```python
import torch

def _softmax(x, axis=-1):
    return torch.softmax(x, dim=axis)
def _gelu(x):
    return torch.nn.functional.gelu(x, approximate="tanh")
def _silu(x):
    return torch.nn.functional.silu(x)
def _sigmoid(x):
    return torch.sigmoid(x)
def _layernorm(x, axis=-1, eps=1e-5):
    m = x.mean(dim=axis, keepdim=True)
    v = x.var(dim=axis, keepdim=True, unbiased=False)
    return (x - m) / torch.sqrt(v + eps)
def _scatter_add(tgt, idx, src, axis=0):
    return tgt.clone().index_add_(axis, idx, src)
def _segment_sum(src, seg, n):
    out = torch.zeros((n,) + src.shape[1:], dtype=src.dtype)
    return out.index_add_(0, seg, src)
def _pad(x, pw):
    flat = tuple(v for pair in reversed(pw) for v in pair)
    return torch.nn.functional.pad(x, flat)

kernel_name = 'sequential_preLN__linear_attn_block__dense_activation_gelu__prompt'

def setup_inputs():

    _w = (lambda a: (lambda t: t.to(torch.bfloat16) if t.is_floating_point() else t)(torch.as_tensor(a)))
    def _A_setup():
        B, S, D = 1, 2048, 640
        return {
            "x": _w((lambda *s: torch.randn(*s, dtype=torch.bfloat16) * 0.05)(B, S, D)),
            "wqkv": _w((lambda *s: torch.randn(*s, dtype=torch.bfloat16) * 0.05)(D, 3 * D)),
            "wo": _w((lambda *s: torch.randn(*s, dtype=torch.bfloat16) * 0.05)(D, D)),
        }
    _A_in = _A_setup()

    def _B_setup():
        B, S, D, F = 1, 2048, 640, 1536
        return {
            "x": _w((lambda *s: torch.randn(*s, dtype=torch.bfloat16) * 0.05)(B, S, D)),
            "w1": _w((lambda *s: torch.randn(*s, dtype=torch.bfloat16) * 0.8)(D, F) * (D ** -0.5)),
            "b1": _w((lambda *s: torch.randn(*s, dtype=torch.bfloat16) * 12.8)(F) * 0.01),
            "w2": _w((lambda *s: torch.randn(*s, dtype=torch.bfloat16) * 0.2)(F, D) * (F ** -0.5)),
            "b2": _w((lambda *s: torch.randn(*s, dtype=torch.bfloat16) * 3.2)(D) * 0.01),
        }
    _B_in = _B_setup()

    return {
        "A_x": _A_in["x"],
        "A_wqkv": _A_in["wqkv"],
        "A_wo": _A_in["wo"],
        "B_x": _B_in["x"],
        "B_w1": _B_in["w1"],
        "B_b1": _B_in["b1"],
        "B_w2": _B_in["w2"],
        "B_b2": _B_in["b2"],
    }

def reference(A_x, A_wqkv, A_wo, B_x, B_w1, B_b1, B_w2, B_b2):
    def _A_ref(x, wqkv, wo):
        B, S, D = x.shape
        H = 32; Dh = D // H
        qkv = (lambda x, *d: x.permute(*d))((x @ wqkv).reshape(B, S, 3, H, Dh), 2, 0, 3, 1, 4)
        q, k, v = qkv[0], qkv[1], qkv[2]
        phi = lambda t: torch.where(t > 0, t + 1, torch.exp(t)) + 1e-6
        pq, pk = phi(q), phi(k)
        kv = torch.einsum("bhsd,bhse->bhde", pk, v)
        z = torch.einsum("bhsd->bhd", pk)
        num = torch.einsum("bhqd,bhde->bhqe", pq, kv)
        den = torch.einsum("bhqd,bhd->bhq", pq, z)[..., None] + 1e-6
        o = num / den
        return (lambda x, *d: x.permute(*d))(o, 0, 2, 1, 3).reshape(B, S, D) @ wo

    def _B_ref(x, w1, b1, w2, b2):
        h = torch.einsum("bsd,df->bsf", x, w1) + b1
        h = _gelu(h)
        return torch.einsum("bsf,fd->bsd", h, w2) + b2

    x = A_x
    h = x + _A_ref(_layernorm(x, axis=-1), A_wqkv, A_wo)
    h2 = h + _B_ref(_layernorm(h, axis=-1), B_w1, B_b1, B_w2, B_b2)
    return h2
```

```asm
; @launch grid=(256,1,1) block=(512,1,1) lds=163840
.amdgcn_target "amdgcn-amd-amdhsa--gfx950"
.text
.globl sequential_preLN__linear_attn_block__dense_activation_gelu__prompt_kernel
.p2align 8
.type sequential_preLN__linear_attn_block__dense_activation_gelu__prompt_kernel,@function
sequential_preLN__linear_attn_block__dense_activation_gelu__prompt_kernel:
    s_cmp_ge_u32 s2, 256
    s_cbranch_scc1 L_exit
    s_load_dwordx4 s[16:19], s[0:1], 0
    s_load_dwordx2 s[36:37], s[0:1], 80
    s_load_dwordx8 s[20:27], s[0:1], 16
    s_load_dwordx4 s[28:31], s[0:1], 48
    s_load_dwordx4 s[32:35], s[0:1], 64
    v_lshrrev_b32 v1, 6, v0
    v_and_b32 v0, 63, v0
    v_readfirstlane_b32 s4, v1
    s_lshr_b32 s38, s2, 6
    s_and_b32 s5, s2, 7
    s_lshl_b32 s5, s5, 2
    s_add_u32 s5, s5, s38
    s_lshr_b32 s6, s2, 3
    s_and_b32 s6, s6, 7
    s_mul_i32 s39, s38, 5
    s_add_u32 s39, s39, 1
    s_lshr_b32 s39, s39, 1
    s_and_b32 s9, s4, 3
    s_lshl_b32 s8, s6, 2
    s_add_u32 s8, s8, s9
    s_cmp_ge_u32 s4, 4
    s_cbranch_scc1 L_loader
    v_and_b32 v1, 15, v0
    v_lshrrev_b32 v2, 4, v0
    v_lshlrev_b32 v3, 4, v0
    v_lshlrev_b32 v6, 3, v0
    v_mov_b32 v4, 0
    v_lshlrev_b32 v27, 7, v0
    s_mul_i32 s10, s2, 50
    v_add_u32 v20, s10, v0
    v_mul_u32_u24 v21, 52429, v20
    v_lshrrev_b32 v21, 20, v21
    v_mul_u32_u24 v22, 20, v21
    v_sub_u32 v22, v20, v22
    v_mul_u32_u24 v21, 3840, v21
    v_lshl_add_u32 v21, v22, 7, v21
    v_add_u32 v24, 1280, v21
    s_cmp_eq_u32 s9, 2
    s_cselect_b32 s11, 7, 3
    s_cselect_b32 s12, 3, 0
    s_add_u32 s12, s12, s39
    s_mov_b32 s13, 21846
    s_cmp_eq_u32 s9, 2
    s_cselect_b32 s13, 9363, s13
    v_mul_u32_u24 v20, s13, v0
    v_lshrrev_b32 v20, 16, v20
    v_mul_u32_u24 v21, s11, v20
    v_sub_u32 v21, v0, v21
    v_add_u32 v21, s12, v21
    v_subrev_u32 v22, 10, v21
    v_min_u32 v21, v21, v22
    v_mul_u32_u24 v20, 1280, v20
    v_lshl_add_u32 v25, v21, 7, v20
    s_waitcnt lgkmcnt(0)
    s_mov_b32 s60, s36
    s_mov_b32 s61, s37
    s_mov_b32 s62, 20971520
    s_mov_b32 s63, 0x00020000
    s_mov_b32 s44, s18
    s_mov_b32 s45, s19
    s_mov_b32 s46, 2457600
    s_mov_b32 s47, 0x00020000
    s_mov_b32 s40, s16
    s_mov_b32 s41, s17
    s_mov_b32 s42, 2621440
    s_mov_b32 s43, 0x00020000
    s_lshl_b32 s11, s5, 3
    s_add_u32 s11, s11, s6
    s_mul_i32 s11, s11, 10240
    s_cmp_eq_u32 s9, 1
    s_cbranch_scc1 L_tw1_1
    s_cmp_eq_u32 s9, 2
    s_cbranch_scc1 L_tw2_2
    s_cmp_eq_u32 s9, 3
    s_cbranch_scc1 L_twe_3
    s_mov_b32 exec_hi, 0x3ffff
    buffer_load_dword v32, v24, s[44:47], 0 offen
    s_branch L_twe_3
L_tw1_1:
    s_mov_b64 exec, 0xffffff
    buffer_load_dword v32, v25, s[40:43], s11 offen
    s_branch L_twe_3
L_tw2_2:
    s_sleep 12
    s_mov_b32 exec_hi, 0xffffff
    buffer_load_dword v32, v25, s[40:43], s11 offen
L_twe_3:
    s_mov_b64 exec, -1
    v_lshlrev_b32 v20, 2, v0
    v_add_u32 v20, 156160, v20
    s_mov_b64 exec, 0xffff
    ds_write_b32 v20, v4
    s_mov_b64 exec, -1
    v_lshrrev_b32 v20, 3, v1
    v_lshlrev_b32 v20, 10, v20
    v_and_b32 v21, 7, v1
    v_lshlrev_b32 v21, 7, v21
    v_add_u32 v20, v20, v21
    v_and_b32 v21, 6, v1
    v_xor_b32 v21, v21, v2
    v_lshlrev_b32 v21, 4, v21
    v_add_u32 v168, v20, v21
    v_xor_b32 v169, 64, v168
    s_lshl_b32 s10, s9, 11
    v_add_u32 v170, s10, v168
    v_add_u32 v171, s10, v169
    v_lshrrev_b32 v20, 2, v1
    v_lshl_add_u32 v20, v2, 2, v20
    v_and_b32 v22, 3, v0
    v_mul_u32_u24 v20, 160, v20
    v_lshlrev_b32 v21, 3, v22
    v_add_u32 v7, v20, v21
    s_mul_i32 s10, s9, 40
    s_add_u32 s10, s10, 81920
    v_add_u32 v20, s10, v20
    v_add_u32 v176, v20, v21
    v_mov_b32 v182, v176
    v_add_u32 v183, 32, v20
    v_add_u32 v184, 35840, v182
    v_add_u32 v185, 35840, v183
    v_cmp_eq_u32 vcc, 0, v22
    v_add_u32 v22, 5112, v21
    v_mov_b32 v23, 32
    v_cndmask_b32 v22, v22, v23, vcc
    v_add_u32 v177, v20, v22
    v_mov_b32 v22, 5152
    v_mov_b32 v23, 5144
    v_cndmask_b32 v22, v22, v23, vcc
    v_add_u32 v178, v20, v22
    v_mov_b32 v36, 0
    v_mov_b32 v37, 0
    v_mov_b32 v38, 0
    v_mov_b32 v39, 0
    v_mov_b32 v40, 0
    v_mov_b32 v41, 0
    v_mov_b32 v42, 0
    v_mov_b32 v43, 0
    v_mov_b32 v44, 0
    v_mov_b32 v45, 0
    v_mov_b32 v46, 0
    v_mov_b32 v47, 0
    v_mov_b32 v48, 0
    v_mov_b32 v49, 0
    v_mov_b32 v50, 0
    v_mov_b32 v51, 0
    v_mov_b32 v52, 0
    v_mov_b32 v53, 0
    v_mov_b32 v54, 0
    v_mov_b32 v55, 0
    v_mov_b32 v56, 0
    v_mov_b32 v57, 0
    v_mov_b32 v58, 0
    v_mov_b32 v59, 0
    v_mov_b32 v60, 0
    v_mov_b32 v61, 0
    v_mov_b32 v62, 0
    v_mov_b32 v63, 0
    v_mov_b32 v64, 0
    v_mov_b32 v65, 0
    v_mov_b32 v66, 0
    v_mov_b32 v67, 0
    v_mov_b32 v68, 0
    v_mov_b32 v69, 0
    v_mov_b32 v70, 0
    v_mov_b32 v71, 0
    v_mov_b32 v72, 0
    v_mov_b32 v73, 0
    v_mov_b32 v74, 0
    v_mov_b32 v75, 0
    v_mov_b32 v76, 0
    v_mov_b32 v77, 0
    v_mov_b32 v78, 0
    v_mov_b32 v79, 0
    v_mov_b32 v80, 0
    v_mov_b32 v81, 0
    v_mov_b32 v82, 0
    v_mov_b32 v83, 0
    v_mov_b32 v84, 0
    v_mov_b32 v85, 0
    v_mov_b32 v86, 0
    v_mov_b32 v87, 0
    v_mov_b32 v88, 0
    v_mov_b32 v89, 0
    v_mov_b32 v90, 0
    v_mov_b32 v91, 0
    v_mov_b32 v92, 0
    v_mov_b32 v93, 0
    v_mov_b32 v94, 0
    v_mov_b32 v95, 0
    v_mov_b32 v96, 0
    v_mov_b32 v100, 0
    v_mov_b32 v28, 0x3f803f80
    v_mov_b32 v97, 0
    v_mov_b32 v101, 0
    v_mov_b32 v29, 0x3f803f80
    v_mov_b32 v98, 0
    v_mov_b32 v102, 0
    v_mov_b32 v30, 0x3f803f80
    v_mov_b32 v99, 0
    v_mov_b32 v103, 0
    v_mov_b32 v31, 0x3f803f80
    v_mov_b32 v136, 0
    v_mov_b32 v137, 0
    v_mov_b32 v138, 0
    v_mov_b32 v139, 0
    v_mov_b32 v140, 0
    v_mov_b32 v141, 0
    v_mov_b32 v142, 0
    v_mov_b32 v143, 0
    v_mov_b32 v144, 0
    v_mov_b32 v145, 0
    v_mov_b32 v146, 0
    v_mov_b32 v147, 0
    v_mov_b32 v148, 0
    v_mov_b32 v149, 0
    v_mov_b32 v150, 0
    v_mov_b32 v151, 0
    v_mov_b32 v152, 0
    v_mov_b32 v153, 0
    v_mov_b32 v154, 0
    v_mov_b32 v155, 0
    v_mov_b32 v156, 0
    v_mov_b32 v157, 0
    v_mov_b32 v158, 0
    v_mov_b32 v159, 0
    v_mov_b32 v160, 0
    v_mov_b32 v161, 0
    v_mov_b32 v162, 0
    v_mov_b32 v163, 0
    v_mov_b32 v164, 0
    v_mov_b32 v165, 0
    v_mov_b32 v166, 0
    v_mov_b32 v167, 0
    s_lshl_b32 s83, s39, 13
    s_mov_b32 s77, 0
    s_mov_b32 s76, 10
    v_add_u32 v172, s83, v168
    v_add_u32 v174, s83, v170
    v_add_u32 v173, s83, v169
    v_add_u32 v175, s83, v171
    v_mov_b32 v179, v176
    v_mov_b32 v180, v177
    v_mov_b32 v181, v178
    s_mov_b32 s84, 0x22222222
    s_mov_b32 s85, 0x22222222
    s_mov_b32 s86, 0x44444444
    s_mov_b32 s87, 0x44444444
    s_mov_b32 s88, 0x88888888
    s_mov_b32 s89, 0x88888888
    s_mov_b32 s90, 0xf000f
    s_mov_b32 s91, 0xf000f
    s_mov_b32 s92, 0x1000100
    s_mov_b32 s93, 0x1000100
    s_waitcnt lgkmcnt(0)
    s_load_dword s7, s[36:37], 0
    s_waitcnt lgkmcnt(0)
    s_mul_i32 s7, s7, 0x9E3779B1
    s_add_u32 s7, s7, 0x7F4A7C15
L_kv_4:
    s_barrier
    ds_read_b128 v[104:107], v172 offset:0
    v_mfma_f32_16x16x32_bf16 v[36:39], v[136:139], v[156:159], v[36:39]
    ds_read_b128 v[108:111], v172 offset:2048
    s_add_u32 s77, s77, 20480
    v_mfma_f32_16x16x32_bf16 v[48:51], v[140:143], v[156:159], v[48:51]
    ds_read_b128 v[112:115], v172 offset:4096
    s_cmp_eq_u32 s77, 61440
    v_mfma_f32_16x16x32_bf16 v[60:63], v[144:147], v[156:159], v[60:63]
    ds_read_b128 v[116:119], v172 offset:6144
    s_cselect_b32 s77, 0, s77
    v_mfma_f32_16x16x32_bf16 v[72:75], v[148:151], v[156:159], v[72:75]
    ds_read_b128 v[120:123], v174
    s_add_u32 s83, s83, 8192
    v_mfma_f32_16x16x32_bf16 v[84:87], v[28:31], v[156:159], v[84:87]
    ds_read_b64_tr_b16 v[124:125], v179 offset:0
    s_cmp_eq_u32 s83, 81920
    v_mfma_f32_16x16x32_bf16 v[40:43], v[136:139], v[160:163], v[40:43]
    ds_read_b64_tr_b16 v[126:127], v179 offset:2560
    s_cselect_b32 s83, 0, s83
    v_mfma_f32_16x16x32_bf16 v[52:55], v[140:143], v[160:163], v[52:55]
    ds_read_b64_tr_b16 v[128:129], v180 offset:0
    v_mfma_f32_16x16x32_bf16 v[64:67], v[144:147], v[160:163], v[64:67]
    ds_read_b64_tr_b16 v[130:131], v180 offset:2560
    v_mfma_f32_16x16x32_bf16 v[76:79], v[148:151], v[160:163], v[76:79]
    ds_read_b64_tr_b16 v[132:133], v181 offset:0
    v_mfma_f32_16x16x32_bf16 v[88:91], v[28:31], v[160:163], v[88:91]
    ds_read_b64_tr_b16 v[134:135], v181 offset:2560
    v_mfma_f32_16x16x32_bf16 v[44:47], v[136:139], v[164:167], v[44:47]
    v_mfma_f32_16x16x32_bf16 v[56:59], v[140:143], v[164:167], v[56:59]
    v_mfma_f32_16x16x32_bf16 v[68:71], v[144:147], v[164:167], v[68:71]
    v_mfma_f32_16x16x32_bf16 v[80:83], v[148:151], v[164:167], v[80:83]
    v_mfma_f32_16x16x32_bf16 v[92:95], v[28:31], v[164:167], v[92:95]
    v_mfma_f32_16x16x32_bf16 v[96:99], v[28:31], v[152:155], v[96:99]
    v_mfma_f32_16x16x32_bf16 v[100:103], v[152:155], v[152:155], v[100:103]
    s_waitcnt lgkmcnt(0)
    ds_read_b128 v[136:139], v173 offset:0
    v_mfma_f32_16x16x32_bf16 v[36:39], v[104:107], v[124:127], v[36:39]
    ds_read_b128 v[140:143], v173 offset:2048
    v_mfma_f32_16x16x32_bf16 v[48:51], v[108:111], v[124:127], v[48:51]
    ds_read_b128 v[144:147], v173 offset:4096
    v_add_u32 v172, s83, v168
    v_mfma_f32_16x16x32_bf16 v[60:63], v[112:115], v[124:127], v[60:63]
    ds_read_b128 v[148:151], v173 offset:6144
    v_add_u32 v174, s83, v170
    v_mfma_f32_16x16x32_bf16 v[72:75], v[116:119], v[124:127], v[72:75]
    ds_read_b128 v[152:155], v175
    s_sub_u32 s76, s76, 1
    v_mfma_f32_16x16x32_bf16 v[84:87], v[28:31], v[124:127], v[84:87]
    ds_read_b64_tr_b16 v[156:157], v179 offset:10240
    s_cmp_lg_u32 s76, 0
    v_mfma_f32_16x16x32_bf16 v[40:43], v[104:107], v[128:131], v[40:43]
    ds_read_b64_tr_b16 v[158:159], v179 offset:12800
    v_mfma_f32_16x16x32_bf16 v[52:55], v[108:111], v[128:131], v[52:55]
    ds_read_b64_tr_b16 v[160:161], v180 offset:10240
    v_mfma_f32_16x16x32_bf16 v[64:67], v[112:115], v[128:131], v[64:67]
    ds_read_b64_tr_b16 v[162:163], v180 offset:12800
    v_mfma_f32_16x16x32_bf16 v[76:79], v[116:119], v[128:131], v[76:79]
    ds_read_b64_tr_b16 v[164:165], v181 offset:10240
    v_mfma_f32_16x16x32_bf16 v[88:91], v[28:31], v[128:131], v[88:91]
    ds_read_b64_tr_b16 v[166:167], v181 offset:12800
    v_mfma_f32_16x16x32_bf16 v[44:47], v[104:107], v[132:135], v[44:47]
    v_add_u32 v173, s83, v169
    v_add_u32 v175, s83, v171
    v_mfma_f32_16x16x32_bf16 v[56:59], v[108:111], v[132:135], v[56:59]
    v_add_u32 v179, s77, v176
    v_add_u32 v180, s77, v177
    v_mfma_f32_16x16x32_bf16 v[68:71], v[112:115], v[132:135], v[68:71]
    v_add_u32 v181, s77, v178
    v_mfma_f32_16x16x32_bf16 v[80:83], v[116:119], v[132:135], v[80:83]
    v_mfma_f32_16x16x32_bf16 v[92:95], v[28:31], v[132:135], v[92:95]
    v_mfma_f32_16x16x32_bf16 v[96:99], v[28:31], v[120:123], v[96:99]
    v_mfma_f32_16x16x32_bf16 v[100:103], v[120:123], v[120:123], v[100:103]
    s_waitcnt lgkmcnt(0)
    s_cbranch_scc1 L_kv_4
    v_mfma_f32_16x16x32_bf16 v[36:39], v[136:139], v[156:159], v[36:39]
    v_mfma_f32_16x16x32_bf16 v[48:51], v[140:143], v[156:159], v[48:51]
    v_mfma_f32_16x16x32_bf16 v[60:63], v[144:147], v[156:159], v[60:63]
    v_mfma_f32_16x16x32_bf16 v[72:75], v[148:151], v[156:159], v[72:75]
    v_mfma_f32_16x16x32_bf16 v[84:87], v[28:31], v[156:159], v[84:87]
    v_mfma_f32_16x16x32_bf16 v[40:43], v[136:139], v[160:163], v[40:43]
    v_mfma_f32_16x16x32_bf16 v[52:55], v[140:143], v[160:163], v[52:55]
    v_mfma_f32_16x16x32_bf16 v[64:67], v[144:147], v[160:163], v[64:67]
    v_mfma_f32_16x16x32_bf16 v[76:79], v[148:151], v[160:163], v[76:79]
    v_mfma_f32_16x16x32_bf16 v[88:91], v[28:31], v[160:163], v[88:91]
    v_mfma_f32_16x16x32_bf16 v[44:47], v[136:139], v[164:167], v[44:47]
    v_mfma_f32_16x16x32_bf16 v[56:59], v[140:143], v[164:167], v[56:59]
    v_mfma_f32_16x16x32_bf16 v[68:71], v[144:147], v[164:167], v[68:71]
    v_mfma_f32_16x16x32_bf16 v[80:83], v[148:151], v[164:167], v[80:83]
    v_mfma_f32_16x16x32_bf16 v[92:95], v[28:31], v[164:167], v[92:95]
    v_mfma_f32_16x16x32_bf16 v[96:99], v[28:31], v[152:155], v[96:99]
    v_mfma_f32_16x16x32_bf16 v[100:103], v[152:155], v[152:155], v[100:103]
    s_lshl_b32 s10, s9, 6
    s_add_u32 s10, s10, 155648
    v_lshl_add_u32 v22, v1, 2, s10
    s_nop 5
    v_cndmask_b32 v20, v100, v101, s[84:85]
    v_mul_f32 v21, 0x3acccccd, v96
    v_cndmask_b32 v20, v20, v102, s[86:87]
    v_cndmask_b32 v20, v20, v103, s[88:89]
    v_mul_f32 v20, 0x3acccccd, v20
    v_fma_f32 v20, -v21, v21, v20
    v_max_f32 v20, 0, v20
    v_add_f32 v20, 0x3727c5ac, v20
    v_rsq_f32 v20, v20
    s_mov_b32 exec_lo, 0x00F0000F
    s_mov_b32 exec_hi, 0xF0000F00
    v_mul_f32 v21, v21, v20
    ds_write_b32 v22, v20
    ds_write_b32 v22, v21 offset:256
    s_mov_b64 exec, -1
    s_waitcnt lgkmcnt(0)
    s_barrier
    v_lshlrev_b32 v20, 4, v2
    v_add_u32 v20, 155648, v20
    ds_read_b128 v[188:191], v20 offset:0
    ds_read_b128 v[204:207], v20 offset:256
    ds_read_b128 v[192:195], v20 offset:64
    ds_read_b128 v[208:211], v20 offset:320
    ds_read_b128 v[196:199], v20 offset:128
    ds_read_b128 v[212:215], v20 offset:384
    ds_read_b128 v[200:203], v20 offset:192
    ds_read_b128 v[216:219], v20 offset:448
    v_mov_b32 v21, 0x358637bd
    v_cndmask_b32 v220, 0, v21, s[90:91]
    v_mov_b32 v221, v220
    v_mov_b32 v222, 0x358637bd
    v_mov_b32 v223, 0x358637bd
    v_mov_b32 v224, 0x3fb8aa3b
    v_mov_b32 v225, 0x3fb8aa3b
    s_mov_b32 s12, 0x358637bd
    s_waitcnt lgkmcnt(0)
    v_pk_fma_f32 v[20:21], v[204:205], v[84:85], v[222:223] neg_lo:[1,0,0] neg_hi:[1,0,0]
    v_pk_fma_f32 v[36:37], v[36:37], v[188:189], v[20:21]
    v_pk_fma_f32 v[22:23], v[206:207], v[84:85], v[222:223] neg_lo:[1,0,0] neg_hi:[1,0,0]
    v_pk_fma_f32 v[38:39], v[38:39], v[190:191], v[22:23]
    v_pk_fma_f32 v[24:25], v[204:205], v[88:89], v[220:221] neg_lo:[1,0,0] neg_hi:[1,0,0]
    v_pk_fma_f32 v[40:41], v[40:41], v[188:189], v[24:25]
    v_pk_fma_f32 v[26:27], v[206:207], v[88:89], v[220:221] neg_lo:[1,0,0] neg_hi:[1,0,0]
    v_pk_fma_f32 v[42:43], v[42:43], v[190:191], v[26:27]
    v_pk_mul_f32 v[20:21], v[204:205], v[92:93]
    v_pk_fma_f32 v[44:45], v[44:45], v[188:189], v[20:21] neg_lo:[0,0,1] neg_hi:[0,0,1]
    v_pk_mul_f32 v[22:23], v[206:207], v[92:93]
    v_pk_fma_f32 v[46:47], v[46:47], v[190:191], v[22:23] neg_lo:[0,0,1] neg_hi:[0,0,1]
    v_pk_mul_f32 v[136:137], v[36:37], v[224:225]
    v_pk_mul_f32 v[138:139], v[38:39], v[224:225]
    v_pk_mul_f32 v[140:141], v[40:41], v[224:225]
    v_pk_mul_f32 v[142:143], v[42:43], v[224:225]
    v_exp_f32_e64 v136, v136 clamp
    v_exp_f32_e64 v137, v137 clamp
    v_exp_f32_e64 v138, v138 clamp
    v_exp_f32_e64 v139, v139 clamp
    v_exp_f32_e64 v140, v140 clamp
    v_exp_f32_e64 v141, v141 clamp
    v_exp_f32_e64 v142, v142 clamp
    v_exp_f32_e64 v143, v143 clamp
    v_max_f32 v144, s12, v36
    v_max_f32 v145, s12, v37
    v_max_f32 v146, s12, v38
    v_max_f32 v147, s12, v39
    v_max_f32 v148, s12, v40
    v_max_f32 v149, s12, v41
    v_max_f32 v150, s12, v42
    v_max_f32 v151, s12, v43
    v_pk_add_f32 v[36:37], v[136:137], v[144:145]
    v_pk_add_f32 v[38:39], v[138:139], v[146:147]
    v_pk_add_f32 v[140:141], v[140:141], v[148:149]
    v_pk_add_f32 v[142:143], v[142:143], v[150:151]
    v_cndmask_b32 v40, v40, v140, s[90:91]
    v_cndmask_b32 v41, v41, v141, s[90:91]
    v_cndmask_b32 v42, v42, v142, s[90:91]
    v_cndmask_b32 v43, v43, v143, s[90:91]
    v_cndmask_b32 v44, v44, 1.0, s[92:93]
    v_cndmask_b32 v45, v45, 1.0, s[92:93]
    v_cndmask_b32 v46, v46, 1.0, s[92:93]
    v_cndmask_b32 v47, v47, 1.0, s[92:93]
    v_cvt_pk_bf16_f32 v104, v36, v37
    v_cvt_pk_bf16_f32 v105, v38, v39
    v_cvt_pk_bf16_f32 v112, v40, v41
    v_cvt_pk_bf16_f32 v113, v42, v43
    v_cvt_pk_bf16_f32 v120, v44, v45
    v_cvt_pk_bf16_f32 v121, v46, v47
    v_pk_fma_f32 v[20:21], v[208:209], v[84:85], v[222:223] neg_lo:[1,0,0] neg_hi:[1,0,0]
    v_pk_fma_f32 v[48:49], v[48:49], v[192:193], v[20:21]
    v_pk_fma_f32 v[22:23], v[210:211], v[84:85], v[222:223] neg_lo:[1,0,0] neg_hi:[1,0,0]
    v_pk_fma_f32 v[50:51], v[50:51], v[194:195], v[22:23]
    v_pk_fma_f32 v[24:25], v[208:209], v[88:89], v[220:221] neg_lo:[1,0,0] neg_hi:[1,0,0]
    v_pk_fma_f32 v[52:53], v[52:53], v[192:193], v[24:25]
    v_pk_fma_f32 v[26:27], v[210:211], v[88:89], v[220:221] neg_lo:[1,0,0] neg_hi:[1,0,0]
    v_pk_fma_f32 v[54:55], v[54:55], v[194:195], v[26:27]
    v_pk_mul_f32 v[20:21], v[208:209], v[92:93]
    v_pk_fma_f32 v[56:57], v[56:57], v[192:193], v[20:21] neg_lo:[0,0,1] neg_hi:[0,0,1]
    v_pk_mul_f32 v[22:23], v[210:211], v[92:93]
    v_pk_fma_f32 v[58:59], v[58:59], v[194:195], v[22:23] neg_lo:[0,0,1] neg_hi:[0,0,1]
    v_pk_mul_f32 v[136:137], v[48:49], v[224:225]
    v_pk_mul_f32 v[138:139], v[50:51], v[224:225]
    v_pk_mul_f32 v[140:141], v[52:53], v[224:225]
    v_pk_mul_f32 v[142:143], v[54:55], v[224:225]
    v_exp_f32_e64 v136, v136 clamp
    v_exp_f32_e64 v137, v137 clamp
    v_exp_f32_e64 v138, v138 clamp
    v_exp_f32_e64 v139, v139 clamp
    v_exp_f32_e64 v140, v140 clamp
    v_exp_f32_e64 v141, v141 clamp
    v_exp_f32_e64 v142, v142 clamp
    v_exp_f32_e64 v143, v143 clamp
    v_max_f32 v144, s12, v48
    v_max_f32 v145, s12, v49
    v_max_f32 v146, s12, v50
    v_max_f32 v147, s12, v51
    v_max_f32 v148, s12, v52
    v_max_f32 v149, s12, v53
    v_max_f32 v150, s12, v54
    v_max_f32 v151, s12, v55
    v_pk_add_f32 v[48:49], v[136:137], v[144:145]
    v_pk_add_f32 v[50:51], v[138:139], v[146:147]
    v_pk_add_f32 v[140:141], v[140:141], v[148:149]
    v_pk_add_f32 v[142:143], v[142:143], v[150:151]
    v_cndmask_b32 v52, v52, v140, s[90:91]
    v_cndmask_b32 v53, v53, v141, s[90:91]
    v_cndmask_b32 v54, v54, v142, s[90:91]
    v_cndmask_b32 v55, v55, v143, s[90:91]
    v_cndmask_b32 v56, v56, 1.0, s[92:93]
    v_cndmask_b32 v57, v57, 1.0, s[92:93]
    v_cndmask_b32 v58, v58, 1.0, s[92:93]
    v_cndmask_b32 v59, v59, 1.0, s[92:93]
    v_cvt_pk_bf16_f32 v106, v48, v49
    v_cvt_pk_bf16_f32 v107, v50, v51
    v_cvt_pk_bf16_f32 v114, v52, v53
    v_cvt_pk_bf16_f32 v115, v54, v55
    v_cvt_pk_bf16_f32 v122, v56, v57
    v_cvt_pk_bf16_f32 v123, v58, v59
    v_pk_fma_f32 v[20:21], v[212:213], v[84:85], v[222:223] neg_lo:[1,0,0] neg_hi:[1,0,0]
    v_pk_fma_f32 v[60:61], v[60:61], v[196:197], v[20:21]
    v_pk_fma_f32 v[22:23], v[214:215], v[84:85], v[222:223] neg_lo:[1,0,0] neg_hi:[1,0,0]
    v_pk_fma_f32 v[62:63], v[62:63], v[198:199], v[22:23]
    v_pk_fma_f32 v[24:25], v[212:213], v[88:89], v[220:221] neg_lo:[1,0,0] neg_hi:[1,0,0]
    v_pk_fma_f32 v[64:65], v[64:65], v[196:197], v[24:25]
    v_pk_fma_f32 v[26:27], v[214:215], v[88:89], v[220:221] neg_lo:[1,0,0] neg_hi:[1,0,0]
    v_pk_fma_f32 v[66:67], v[66:67], v[198:199], v[26:27]
    v_pk_mul_f32 v[20:21], v[212:213], v[92:93]
    v_pk_fma_f32 v[68:69], v[68:69], v[196:197], v[20:21] neg_lo:[0,0,1] neg_hi:[0,0,1]
    v_pk_mul_f32 v[22:23], v[214:215], v[92:93]
    v_pk_fma_f32 v[70:71], v[70:71], v[198:199], v[22:23] neg_lo:[0,0,1] neg_hi:[0,0,1]
    v_pk_mul_f32 v[136:137], v[60:61], v[224:225]
    v_pk_mul_f32 v[138:139], v[62:63], v[224:225]
    v_pk_mul_f32 v[140:141], v[64:65], v[224:225]
    v_pk_mul_f32 v[142:143], v[66:67], v[224:225]
    v_exp_f32_e64 v136, v136 clamp
    v_exp_f32_e64 v137, v137 clamp
    v_exp_f32_e64 v138, v138 clamp
    v_exp_f32_e64 v139, v139 clamp
    v_exp_f32_e64 v140, v140 clamp
    v_exp_f32_e64 v141, v141 clamp
    v_exp_f32_e64 v142, v142 clamp
    v_exp_f32_e64 v143, v143 clamp
    v_max_f32 v144, s12, v60
    v_max_f32 v145, s12, v61
    v_max_f32 v146, s12, v62
    v_max_f32 v147, s12, v63
    v_max_f32 v148, s12, v64
    v_max_f32 v149, s12, v65
    v_max_f32 v150, s12, v66
    v_max_f32 v151, s12, v67
    v_pk_add_f32 v[60:61], v[136:137], v[144:145]
    v_pk_add_f32 v[62:63], v[138:139], v[146:147]
    v_pk_add_f32 v[140:141], v[140:141], v[148:149]
    v_pk_add_f32 v[142:143], v[142:143], v[150:151]
    v_cndmask_b32 v64, v64, v140, s[90:91]
    v_cndmask_b32 v65, v65, v141, s[90:91]
    v_cndmask_b32 v66, v66, v142, s[90:91]
    v_cndmask_b32 v67, v67, v143, s[90:91]
    v_cndmask_b32 v68, v68, 1.0, s[92:93]
    v_cndmask_b32 v69, v69, 1.0, s[92:93]
    v_cndmask_b32 v70, v70, 1.0, s[92:93]
    v_cndmask_b32 v71, v71, 1.0, s[92:93]
    v_cvt_pk_bf16_f32 v108, v60, v61
    v_cvt_pk_bf16_f32 v109, v62, v63
    v_cvt_pk_bf16_f32 v116, v64, v65
    v_cvt_pk_bf16_f32 v117, v66, v67
    v_cvt_pk_bf16_f32 v124, v68, v69
    v_cvt_pk_bf16_f32 v125, v70, v71
    v_pk_fma_f32 v[20:21], v[216:217], v[84:85], v[222:223] neg_lo:[1,0,0] neg_hi:[1,0,0]
    v_pk_fma_f32 v[72:73], v[72:73], v[200:201], v[20:21]
    v_pk_fma_f32 v[22:23], v[218:219], v[84:85], v[222:223] neg_lo:[1,0,0] neg_hi:[1,0,0]
    v_pk_fma_f32 v[74:75], v[74:75], v[202:203], v[22:23]
    v_pk_fma_f32 v[24:25], v[216:217], v[88:89], v[220:221] neg_lo:[1,0,0] neg_hi:[1,0,0]
    v_pk_fma_f32 v[76:77], v[76:77], v[200:201], v[24:25]
    v_pk_fma_f32 v[26:27], v[218:219], v[88:89], v[220:221] neg_lo:[1,0,0] neg_hi:[1,0,0]
    v_pk_fma_f32 v[78:79], v[78:79], v[202:203], v[26:27]
    v_pk_mul_f32 v[20:21], v[216:217], v[92:93]
    v_pk_fma_f32 v[80:81], v[80:81], v[200:201], v[20:21] neg_lo:[0,0,1] neg_hi:[0,0,1]
    v_pk_mul_f32 v[22:23], v[218:219], v[92:93]
    v_pk_fma_f32 v[82:83], v[82:83], v[202:203], v[22:23] neg_lo:[0,0,1] neg_hi:[0,0,1]
    v_pk_mul_f32 v[136:137], v[72:73], v[224:225]
    v_pk_mul_f32 v[138:139], v[74:75], v[224:225]
    v_pk_mul_f32 v[140:141], v[76:77], v[224:225]
    v_pk_mul_f32 v[142:143], v[78:79], v[224:225]
    v_exp_f32_e64 v136, v136 clamp
    v_exp_f32_e64 v137, v137 clamp
    v_exp_f32_e64 v138, v138 clamp
    v_exp_f32_e64 v139, v139 clamp
    v_exp_f32_e64 v140, v140 clamp
    v_exp_f32_e64 v141, v141 clamp
    v_exp_f32_e64 v142, v142 clamp
    v_exp_f32_e64 v143, v143 clamp
    v_max_f32 v144, s12, v72
    v_max_f32 v145, s12, v73
    v_max_f32 v146, s12, v74
    v_max_f32 v147, s12, v75
    v_max_f32 v148, s12, v76
    v_max_f32 v149, s12, v77
    v_max_f32 v150, s12, v78
    v_max_f32 v151, s12, v79
    v_pk_add_f32 v[72:73], v[136:137], v[144:145]
    v_pk_add_f32 v[74:75], v[138:139], v[146:147]
    v_pk_add_f32 v[140:141], v[140:141], v[148:149]
    v_pk_add_f32 v[142:143], v[142:143], v[150:151]
    v_cndmask_b32 v76, v76, v140, s[90:91]
    v_cndmask_b32 v77, v77, v141, s[90:91]
    v_cndmask_b32 v78, v78, v142, s[90:91]
    v_cndmask_b32 v79, v79, v143, s[90:91]
    v_cndmask_b32 v80, v80, 1.0, s[92:93]
    v_cndmask_b32 v81, v81, 1.0, s[92:93]
    v_cndmask_b32 v82, v82, 1.0, s[92:93]
    v_cndmask_b32 v83, v83, 1.0, s[92:93]
    v_cvt_pk_bf16_f32 v110, v72, v73
    v_cvt_pk_bf16_f32 v111, v74, v75
    v_cvt_pk_bf16_f32 v118, v76, v77
    v_cvt_pk_bf16_f32 v119, v78, v79
    v_cvt_pk_bf16_f32 v126, v80, v81
    v_cvt_pk_bf16_f32 v127, v82, v83
    s_mov_b32 s96, 0x05030201
    s_mov_b32 s97, 0x05040302
    v_mov_b32 v26, s7
    s_lshl_b32 s10, s8, 5
    s_add_u32 s10, s10, s5
    s_mul_i32 s10, s10, 2560
    s_add_u32 s10, s10, 65536
    v_mfma_f32_16x16x32_bf16 v[188:191], v[104:107], v[112:115], 0
    v_mfma_f32_16x16x32_bf16 v[192:195], v[104:107], v[120:123], 0
    v_mfma_f32_16x16x32_bf16 v[196:199], v[112:115], v[112:115], 0
    v_mfma_f32_16x16x32_bf16 v[200:203], v[112:115], v[120:123], 0
    v_mfma_f32_16x16x32_bf16 v[188:191], v[108:111], v[116:119], v[188:191]
    v_mfma_f32_16x16x32_bf16 v[192:195], v[108:111], v[124:127], v[192:195]
    v_mfma_f32_16x16x32_bf16 v[196:199], v[116:119], v[116:119], v[196:199]
    v_mfma_f32_16x16x32_bf16 v[200:203], v[116:119], v[124:127], v[200:203]
    v_mov_b32 v36, 0
    v_mov_b32 v37, 0
    v_mov_b32 v38, 0
    v_mov_b32 v39, 0
    v_mov_b32 v40, 0
    v_perm_b32 v204, v189, v188, s96
    v_perm_b32 v205, v26, v189, s97
    v_perm_b32 v206, v191, v190, s96
    v_perm_b32 v207, v26, v191, s97
    v_perm_b32 v208, v193, v192, s96
    v_perm_b32 v209, v26, v193, s97
    v_perm_b32 v210, v195, v194, s96
    v_perm_b32 v211, v26, v195, s97
    v_perm_b32 v212, v197, v196, s96
    v_perm_b32 v213, v26, v197, s97
    v_perm_b32 v214, v199, v198, s96
    v_perm_b32 v215, v26, v199, s97
    v_perm_b32 v216, v201, v200, s96
    v_perm_b32 v217, v26, v201, s97
    v_perm_b32 v218, v203, v202, s96
    v_perm_b32 v219, v26, v203, s97
    buffer_store_dwordx4 v[204:207], v3, s[60:63], s10 offen sc1
    buffer_store_dwordx4 v[208:211], v3, s[60:63], s10 offen offset:1024 sc1
    s_mov_b64 exec, 0xffff
    buffer_store_dwordx4 v[212:215], v3, s[60:63], s10 offen offset:2048 sc1
    buffer_store_dwordx4 v[216:219], v3, s[60:63], s10 offen offset:2304 sc1
    s_mov_b64 exec, -1
    v_mov_b32 v41, 0
    v_mov_b32 v42, 0
    v_mov_b32 v43, 0
    v_mov_b32 v44, 0
    v_mov_b32 v45, 0
    v_mov_b32 v46, 0
    v_mov_b32 v47, 0
    v_mov_b32 v48, 0
    v_mov_b32 v49, 0
    v_mov_b32 v50, 0
    v_mov_b32 v51, 0
    v_mov_b32 v52, 0
    v_mov_b32 v53, 0
    v_mov_b32 v54, 0
    v_mov_b32 v55, 0
    v_mov_b32 v56, 0
    v_mov_b32 v57, 0
    v_mov_b32 v58, 0
    v_mov_b32 v59, 0
    v_mov_b32 v60, 0
    v_mov_b32 v61, 0
    v_mov_b32 v62, 0
    v_mov_b32 v63, 0
    v_mov_b32 v64, 0
    v_mov_b32 v65, 0
    v_mov_b32 v66, 0
    v_mov_b32 v67, 0
    v_mov_b32 v84, 0
    v_mov_b32 v85, 0
    v_mov_b32 v86, 0
    v_mov_b32 v87, 0
    v_mov_b32 v88, 0
    v_mov_b32 v89, 0
    v_mov_b32 v90, 0
    v_mov_b32 v91, 0
    s_lshl_b32 s83, s39, 13
    v_add_u32 v172, s83, v168
    v_add_u32 v173, s83, v169
    s_barrier
    ds_read_b128 v[104:107], v172 offset:0
    ds_read_b128 v[108:111], v172 offset:2048
    ds_read_b128 v[112:115], v172 offset:4096
    ds_read_b128 v[116:119], v172 offset:6144
    ds_read_b64_tr_b16 v[124:125], v182 offset:0
    ds_read_b64_tr_b16 v[126:127], v182 offset:2560
    ds_read_b64_tr_b16 v[128:129], v183 offset:0
    ds_read_b64_tr_b16 v[130:131], v183 offset:2560
    s_waitcnt lgkmcnt(0)
    ds_read_b128 v[136:139], v173 offset:0
    v_mfma_f32_16x16x32_bf16 v[36:39], v[124:127], v[104:107], v[36:39]
    ds_read_b128 v[140:143], v173 offset:2048
    v_mfma_f32_16x16x32_bf16 v[44:47], v[124:127], v[108:111], v[44:47]
    ds_read_b128 v[144:147], v173 offset:4096
    v_mfma_f32_16x16x32_bf16 v[52:55], v[124:127], v[112:115], v[52:55]
    ds_read_b128 v[148:151], v173 offset:6144
    v_mfma_f32_16x16x32_bf16 v[60:63], v[124:127], v[116:119], v[60:63]
    ds_read_b64_tr_b16 v[156:157], v182 offset:5120
    v_mfma_f32_16x16x32_bf16 v[84:87], v[124:127], v[28:31], v[84:87]
    ds_read_b64_tr_b16 v[158:159], v182 offset:7680
    v_mfma_f32_16x16x32_bf16 v[40:43], v[128:131], v[104:107], v[40:43]
    ds_read_b64_tr_b16 v[160:161], v183 offset:5120
    v_mfma_f32_16x16x32_bf16 v[48:51], v[128:131], v[108:111], v[48:51]
    ds_read_b64_tr_b16 v[162:163], v183 offset:7680
    v_mfma_f32_16x16x32_bf16 v[56:59], v[128:131], v[112:115], v[56:59]
    v_mfma_f32_16x16x32_bf16 v[64:67], v[128:131], v[116:119], v[64:67]
    v_mfma_f32_16x16x32_bf16 v[88:91], v[128:131], v[28:31], v[88:91]
    s_waitcnt lgkmcnt(0)
    s_add_u32 s83, s83, 8192
    s_cmp_eq_u32 s83, 81920
    s_cselect_b32 s83, 0, s83
    v_add_u32 v172, s83, v168
    ds_read_b128 v[104:107], v172 offset:0
    v_mfma_f32_16x16x32_bf16 v[36:39], v[156:159], v[136:139], v[36:39]
    ds_read_b128 v[108:111], v172 offset:2048
    v_and_b32 v20, 7, v1
    v_mfma_f32_16x16x32_bf16 v[44:47], v[156:159], v[140:143], v[44:47]
    ds_read_b128 v[112:115], v172 offset:4096
    v_lshrrev_b32 v21, 3, v1
    v_mfma_f32_16x16x32_bf16 v[52:55], v[156:159], v[144:147], v[52:55]
    ds_read_b128 v[116:119], v172 offset:6144
    s_lshl_b32 s10, s9, 1
    v_mfma_f32_16x16x32_bf16 v[60:63], v[156:159], v[148:151], v[60:63]
    ds_read_b64_tr_b16 v[124:125], v182 offset:10240
    v_add_u32 v21, s10, v21
    v_mfma_f32_16x16x32_bf16 v[84:87], v[156:159], v[28:31], v[84:87]
    ds_read_b64_tr_b16 v[126:127], v182 offset:12800
    v_lshlrev_b32 v21, 10, v21
    v_mfma_f32_16x16x32_bf16 v[40:43], v[160:163], v[136:139], v[40:43]
    ds_read_b64_tr_b16 v[128:129], v183 offset:10240
    v_lshl_add_u32 v21, v20, 7, v21
    v_mfma_f32_16x16x32_bf16 v[48:51], v[160:163], v[140:143], v[48:51]
    ds_read_b64_tr_b16 v[130:131], v183 offset:12800
    v_and_b32 v20, 6, v20
    v_mfma_f32_16x16x32_bf16 v[56:59], v[160:163], v[144:147], v[56:59]
    s_mul_i32 s10, s6, 160
    v_mfma_f32_16x16x32_bf16 v[64:67], v[160:163], v[148:151], v[64:67]
    v_add_u32 v173, s83, v169
    v_mfma_f32_16x16x32_bf16 v[88:91], v[160:163], v[28:31], v[88:91]
    s_waitcnt lgkmcnt(0)
    ds_read_b128 v[136:139], v173 offset:0
    v_mfma_f32_16x16x32_bf16 v[36:39], v[124:127], v[104:107], v[36:39]
    ds_read_b128 v[140:143], v173 offset:2048
    s_add_u32 s11, s10, 0
    v_mfma_f32_16x16x32_bf16 v[44:47], v[124:127], v[108:111], v[44:47]
    ds_read_b128 v[144:147], v173 offset:4096
    v_lshl_add_u32 v22, v2, 3, s11
    v_mfma_f32_16x16x32_bf16 v[52:55], v[124:127], v[112:115], v[52:55]
    ds_read_b128 v[148:151], v173 offset:6144
    v_lshrrev_b32 v23, 7, v22
    v_mfma_f32_16x16x32_bf16 v[60:63], v[124:127], v[116:119], v[60:63]
    ds_read_b64_tr_b16 v[156:157], v182 offset:15360
    v_lshlrev_b32 v23, 13, v23
    v_mfma_f32_16x16x32_bf16 v[84:87], v[124:127], v[28:31], v[84:87]
    ds_read_b64_tr_b16 v[158:159], v182 offset:17920
    v_add_u32 v23, v23, v21
    v_mfma_f32_16x16x32_bf16 v[40:43], v[128:131], v[104:107], v[40:43]
    ds_read_b64_tr_b16 v[160:161], v183 offset:15360
    v_bfe_u32 v24, v22, 4, 3
    v_mfma_f32_16x16x32_bf16 v[48:51], v[128:131], v[108:111], v[48:51]
    ds_read_b64_tr_b16 v[162:163], v183 offset:17920
    v_xor_b32 v24, v24, v20
    v_mfma_f32_16x16x32_bf16 v[56:59], v[128:131], v[112:115], v[56:59]
    v_lshl_add_u32 v23, v24, 4, v23
    v_mfma_f32_16x16x32_bf16 v[64:67], v[128:131], v[116:119], v[64:67]
    v_mfma_f32_16x16x32_bf16 v[88:91], v[128:131], v[28:31], v[88:91]
    s_waitcnt lgkmcnt(0)
    s_add_u32 s83, s83, 8192
    s_cmp_eq_u32 s83, 81920
    s_cselect_b32 s83, 0, s83
    v_add_u32 v172, s83, v168
    ds_read_b128 v[104:107], v172 offset:0
    v_mfma_f32_16x16x32_bf16 v[36:39], v[156:159], v[136:139], v[36:39]
    ds_read_b128 v[108:111], v172 offset:2048
    v_and_b32 v22, 8, v22
    v_mfma_f32_16x16x32_bf16 v[44:47], v[156:159], v[140:143], v[44:47]
    ds_read_b128 v[112:115], v172 offset:4096
    v_add_u32 v206, v23, v22
    v_mfma_f32_16x16x32_bf16 v[52:55], v[156:159], v[144:147], v[52:55]
    ds_read_b128 v[116:119], v172 offset:6144
    s_add_u32 s11, s10, 32
    v_mfma_f32_16x16x32_bf16 v[60:63], v[156:159], v[148:151], v[60:63]
    ds_read_b64_tr_b16 v[124:125], v182 offset:20480
    v_lshl_add_u32 v22, v2, 3, s11
    v_mfma_f32_16x16x32_bf16 v[84:87], v[156:159], v[28:31], v[84:87]
    ds_read_b64_tr_b16 v[126:127], v182 offset:23040
    v_lshrrev_b32 v23, 7, v22
    v_mfma_f32_16x16x32_bf16 v[40:43], v[160:163], v[136:139], v[40:43]
    ds_read_b64_tr_b16 v[128:129], v183 offset:20480
    v_lshlrev_b32 v23, 13, v23
    v_mfma_f32_16x16x32_bf16 v[48:51], v[160:163], v[140:143], v[48:51]
    ds_read_b64_tr_b16 v[130:131], v183 offset:23040
    v_add_u32 v23, v23, v21
    v_mfma_f32_16x16x32_bf16 v[56:59], v[160:163], v[144:147], v[56:59]
    v_bfe_u32 v24, v22, 4, 3
    v_mfma_f32_16x16x32_bf16 v[64:67], v[160:163], v[148:151], v[64:67]
    v_add_u32 v173, s83, v169
    v_mfma_f32_16x16x32_bf16 v[88:91], v[160:163], v[28:31], v[88:91]
    s_waitcnt lgkmcnt(0)
    ds_read_b128 v[136:139], v173 offset:0
    v_mfma_f32_16x16x32_bf16 v[36:39], v[124:127], v[104:107], v[36:39]
    ds_read_b128 v[140:143], v173 offset:2048
    v_xor_b32 v24, v24, v20
    v_mfma_f32_16x16x32_bf16 v[44:47], v[124:127], v[108:111], v[44:47]
    ds_read_b128 v[144:147], v173 offset:4096
    v_lshl_add_u32 v23, v24, 4, v23
    v_mfma_f32_16x16x32_bf16 v[52:55], v[124:127], v[112:115], v[52:55]
    ds_read_b128 v[148:151], v173 offset:6144
    v_and_b32 v22, 8, v22
    v_mfma_f32_16x16x32_bf16 v[60:63], v[124:127], v[116:119], v[60:63]
    ds_read_b64_tr_b16 v[156:157], v182 offset:25600
    v_add_u32 v207, v23, v22
    v_mfma_f32_16x16x32_bf16 v[84:87], v[124:127], v[28:31], v[84:87]
    ds_read_b64_tr_b16 v[158:159], v182 offset:28160
    s_add_u32 s11, s10, 64
    v_mfma_f32_16x16x32_bf16 v[40:43], v[128:131], v[104:107], v[40:43]
    ds_read_b64_tr_b16 v[160:161], v183 offset:25600
    v_lshl_add_u32 v22, v2, 3, s11
    v_mfma_f32_16x16x32_bf16 v[48:51], v[128:131], v[108:111], v[48:51]
    ds_read_b64_tr_b16 v[162:163], v183 offset:28160
    v_lshrrev_b32 v23, 7, v22
    v_mfma_f32_16x16x32_bf16 v[56:59], v[128:131], v[112:115], v[56:59]
    v_lshlrev_b32 v23, 13, v23
    v_mfma_f32_16x16x32_bf16 v[64:67], v[128:131], v[116:119], v[64:67]
    v_mfma_f32_16x16x32_bf16 v[88:91], v[128:131], v[28:31], v[88:91]
    s_waitcnt lgkmcnt(0)
    s_barrier
    s_add_u32 s83, s83, 8192
    s_cmp_eq_u32 s83, 81920
    s_cselect_b32 s83, 0, s83
    v_add_u32 v172, s83, v168
    ds_read_b128 v[104:107], v172 offset:0
    v_mfma_f32_16x16x32_bf16 v[36:39], v[156:159], v[136:139], v[36:39]
    ds_read_b128 v[108:111], v172 offset:2048
    v_add_u32 v23, v23, v21
    v_mfma_f32_16x16x32_bf16 v[44:47], v[156:159], v[140:143], v[44:47]
    ds_read_b128 v[112:115], v172 offset:4096
    v_bfe_u32 v24, v22, 4, 3
    v_mfma_f32_16x16x32_bf16 v[52:55], v[156:159], v[144:147], v[52:55]
    ds_read_b128 v[116:119], v172 offset:6144
    v_xor_b32 v24, v24, v20
    v_mfma_f32_16x16x32_bf16 v[60:63], v[156:159], v[148:151], v[60:63]
    ds_read_b64_tr_b16 v[124:125], v182 offset:30720
    v_lshl_add_u32 v23, v24, 4, v23
    v_mfma_f32_16x16x32_bf16 v[84:87], v[156:159], v[28:31], v[84:87]
    ds_read_b64_tr_b16 v[126:127], v182 offset:33280
    v_and_b32 v22, 8, v22
    v_mfma_f32_16x16x32_bf16 v[40:43], v[160:163], v[136:139], v[40:43]
    ds_read_b64_tr_b16 v[128:129], v183 offset:30720
    v_add_u32 v208, v23, v22
    v_mfma_f32_16x16x32_bf16 v[48:51], v[160:163], v[140:143], v[48:51]
    ds_read_b64_tr_b16 v[130:131], v183 offset:33280
    s_add_u32 s11, s10, 96
    v_mfma_f32_16x16x32_bf16 v[56:59], v[160:163], v[144:147], v[56:59]
    v_lshl_add_u32 v22, v2, 3, s11
    v_mfma_f32_16x16x32_bf16 v[64:67], v[160:163], v[148:151], v[64:67]
    v_add_u32 v173, s83, v169
    v_mfma_f32_16x16x32_bf16 v[88:91], v[160:163], v[28:31], v[88:91]
    s_waitcnt lgkmcnt(0)
    ds_read_b128 v[136:139], v173 offset:0
    v_mfma_f32_16x16x32_bf16 v[36:39], v[124:127], v[104:107], v[36:39]
    ds_read_b128 v[140:143], v173 offset:2048
    v_lshrrev_b32 v23, 7, v22
    v_mfma_f32_16x16x32_bf16 v[44:47], v[124:127], v[108:111], v[44:47]
    ds_read_b128 v[144:147], v173 offset:4096
    v_lshlrev_b32 v23, 13, v23
    v_mfma_f32_16x16x32_bf16 v[52:55], v[124:127], v[112:115], v[52:55]
    ds_read_b128 v[148:151], v173 offset:6144
    v_add_u32 v23, v23, v21
    v_mfma_f32_16x16x32_bf16 v[60:63], v[124:127], v[116:119], v[60:63]
    ds_read_b64_tr_b16 v[156:157], v184 offset:0
    v_bfe_u32 v24, v22, 4, 3
    v_mfma_f32_16x16x32_bf16 v[84:87], v[124:127], v[28:31], v[84:87]
    ds_read_b64_tr_b16 v[158:159], v184 offset:2560
    v_xor_b32 v24, v24, v20
    v_mfma_f32_16x16x32_bf16 v[40:43], v[128:131], v[104:107], v[40:43]
    ds_read_b64_tr_b16 v[160:161], v185 offset:0
    v_lshl_add_u32 v23, v24, 4, v23
    v_mfma_f32_16x16x32_bf16 v[48:51], v[128:131], v[108:111], v[48:51]
    ds_read_b64_tr_b16 v[162:163], v185 offset:2560
    v_and_b32 v22, 8, v22
    v_mfma_f32_16x16x32_bf16 v[56:59], v[128:131], v[112:115], v[56:59]
    v_add_u32 v209, v23, v22
    v_mfma_f32_16x16x32_bf16 v[64:67], v[128:131], v[116:119], v[64:67]
    v_mfma_f32_16x16x32_bf16 v[88:91], v[128:131], v[28:31], v[88:91]
    s_waitcnt lgkmcnt(0)
    s_add_u32 s83, s83, 8192
    s_cmp_eq_u32 s83, 81920
    s_cselect_b32 s83, 0, s83
    v_add_u32 v172, s83, v168
    ds_read_b128 v[104:107], v172 offset:0
    v_mfma_f32_16x16x32_bf16 v[36:39], v[156:159], v[136:139], v[36:39]
    ds_read_b128 v[108:111], v172 offset:2048
    s_add_u32 s11, s10, 128
    v_mfma_f32_16x16x32_bf16 v[44:47], v[156:159], v[140:143], v[44:47]
    ds_read_b128 v[112:115], v172 offset:4096
    v_lshl_add_u32 v22, v2, 3, s11
    v_mfma_f32_16x16x32_bf16 v[52:55], v[156:159], v[144:147], v[52:55]
    ds_read_b128 v[116:119], v172 offset:6144
    v_lshrrev_b32 v23, 7, v22
    v_mfma_f32_16x16x32_bf16 v[60:63], v[156:159], v[148:151], v[60:63]
    ds_read_b64_tr_b16 v[124:125], v184 offset:5120
    v_lshlrev_b32 v23, 13, v23
    v_mfma_f32_16x16x32_bf16 v[84:87], v[156:159], v[28:31], v[84:87]
    ds_read_b64_tr_b16 v[126:127], v184 offset:7680
    v_add_u32 v23, v23, v21
    v_mfma_f32_16x16x32_bf16 v[40:43], v[160:163], v[136:139], v[40:43]
    ds_read_b64_tr_b16 v[128:129], v185 offset:5120
    v_bfe_u32 v24, v22, 4, 3
    v_mfma_f32_16x16x32_bf16 v[48:51], v[160:163], v[140:143], v[48:51]
    ds_read_b64_tr_b16 v[130:131], v185 offset:7680
    v_xor_b32 v24, v24, v20
    v_mfma_f32_16x16x32_bf16 v[56:59], v[160:163], v[144:147], v[56:59]
    v_lshl_add_u32 v23, v24, 4, v23
    v_mfma_f32_16x16x32_bf16 v[64:67], v[160:163], v[148:151], v[64:67]
    v_add_u32 v173, s83, v169
    v_mfma_f32_16x16x32_bf16 v[88:91], v[160:163], v[28:31], v[88:91]
    s_waitcnt lgkmcnt(0)
    ds_read_b128 v[136:139], v173 offset:0
    v_mfma_f32_16x16x32_bf16 v[36:39], v[124:127], v[104:107], v[36:39]
    ds_read_b128 v[140:143], v173 offset:2048
    v_and_b32 v22, 8, v22
    v_mfma_f32_16x16x32_bf16 v[44:47], v[124:127], v[108:111], v[44:47]
    ds_read_b128 v[144:147], v173 offset:4096
    v_add_u32 v210, v23, v22
    v_mfma_f32_16x16x32_bf16 v[52:55], v[124:127], v[112:115], v[52:55]
    ds_read_b128 v[148:151], v173 offset:6144
    v_lshlrev_b32 v211, 2, v1
    v_mfma_f32_16x16x32_bf16 v[60:63], v[124:127], v[116:119], v[60:63]
    ds_read_b64_tr_b16 v[156:157], v184 offset:10240
    v_add_u32 v211, 155648, v211
    v_mfma_f32_16x16x32_bf16 v[84:87], v[124:127], v[28:31], v[84:87]
    ds_read_b64_tr_b16 v[158:159], v184 offset:12800
    v_lshlrev_b32 v20, 8, v2
    v_mfma_f32_16x16x32_bf16 v[40:43], v[128:131], v[104:107], v[40:43]
    ds_read_b64_tr_b16 v[160:161], v185 offset:10240
    v_lshlrev_b32 v21, 4, v1
    v_mfma_f32_16x16x32_bf16 v[48:51], v[128:131], v[108:111], v[48:51]
    ds_read_b64_tr_b16 v[162:163], v185 offset:12800
    v_cmp_gt_u32 vcc, 12, v1
    v_mfma_f32_16x16x32_bf16 v[56:59], v[128:131], v[112:115], v[56:59]
    v_add_u32 v22, 64, v21
    v_mfma_f32_16x16x32_bf16 v[64:67], v[128:131], v[116:119], v[64:67]
    v_mfma_f32_16x16x32_bf16 v[88:91], v[128:131], v[28:31], v[88:91]
    s_waitcnt lgkmcnt(0)
    s_add_u32 s83, s83, 8192
    s_cmp_eq_u32 s83, 81920
    s_cselect_b32 s83, 0, s83
    v_add_u32 v172, s83, v168
    ds_read_b128 v[104:107], v172 offset:0
    v_mfma_f32_16x16x32_bf16 v[36:39], v[156:159], v[136:139], v[36:39]
    ds_read_b128 v[108:111], v172 offset:2048
    v_add_u32 v23, 832, v21
    v_mfma_f32_16x16x32_bf16 v[44:47], v[156:159], v[140:143], v[44:47]
    ds_read_b128 v[112:115], v172 offset:4096
    v_cndmask_b32 v22, v23, v22, vcc
    v_mfma_f32_16x16x32_bf16 v[52:55], v[156:159], v[144:147], v[52:55]
    ds_read_b128 v[116:119], v172 offset:6144
    v_add_u32 v200, v20, v22
    v_mfma_f32_16x16x32_bf16 v[60:63], v[156:159], v[148:151], v[60:63]
    ds_read_b64_tr_b16 v[124:125], v184 offset:15360
    v_add_u32 v22, 2112, v21
    v_mfma_f32_16x16x32_bf16 v[84:87], v[156:159], v[28:31], v[84:87]
    ds_read_b64_tr_b16 v[126:127], v184 offset:17920
    v_add_u32 v23, 2112, v21
    v_mfma_f32_16x16x32_bf16 v[40:43], v[160:163], v[136:139], v[40:43]
    ds_read_b64_tr_b16 v[128:129], v185 offset:15360
    v_cndmask_b32 v22, v23, v22, vcc
    v_mfma_f32_16x16x32_bf16 v[48:51], v[160:163], v[140:143], v[48:51]
    ds_read_b64_tr_b16 v[130:131], v185 offset:17920
    v_cmp_eq_u32 vcc, 0, v2
    v_mfma_f32_16x16x32_bf16 v[56:59], v[160:163], v[144:147], v[56:59]
    v_mov_b32 v23, 0x7ff00000
    v_mfma_f32_16x16x32_bf16 v[64:67], v[160:163], v[148:151], v[64:67]
    v_add_u32 v173, s83, v169
    v_mfma_f32_16x16x32_bf16 v[88:91], v[160:163], v[28:31], v[88:91]
    s_waitcnt lgkmcnt(0)
    ds_read_b128 v[136:139], v173 offset:0
    v_mfma_f32_16x16x32_bf16 v[36:39], v[124:127], v[104:107], v[36:39]
    ds_read_b128 v[140:143], v173 offset:2048
    v_min_u32 v21, 3, v1
    v_mfma_f32_16x16x32_bf16 v[44:47], v[124:127], v[108:111], v[44:47]
    ds_read_b128 v[144:147], v173 offset:4096
    v_cndmask_b32 v201, v23, v22, vcc
    v_mfma_f32_16x16x32_bf16 v[52:55], v[124:127], v[112:115], v[52:55]
    ds_read_b128 v[148:151], v173 offset:6144
    v_lshlrev_b32 v21, 4, v21
    v_mfma_f32_16x16x32_bf16 v[60:63], v[124:127], v[116:119], v[60:63]
    ds_read_b64_tr_b16 v[156:157], v184 offset:20480
    v_add_u32 v22, 1088, v21
    v_mfma_f32_16x16x32_bf16 v[84:87], v[124:127], v[28:31], v[84:87]
    ds_read_b64_tr_b16 v[158:159], v184 offset:23040
    v_add_u32 v202, v20, v22
    v_mfma_f32_16x16x32_bf16 v[40:43], v[128:131], v[104:107], v[40:43]
    ds_read_b64_tr_b16 v[160:161], v185 offset:20480
    v_add_u32 v22, 2368, v21
    v_mfma_f32_16x16x32_bf16 v[48:51], v[128:131], v[108:111], v[48:51]
    ds_read_b64_tr_b16 v[162:163], v185 offset:23040
    v_cndmask_b32 v203, v23, v22, vcc
    v_mfma_f32_16x16x32_bf16 v[56:59], v[128:131], v[112:115], v[56:59]
    v_add_u32 v204, 1152, v20
    v_mfma_f32_16x16x32_bf16 v[64:67], v[128:131], v[116:119], v[64:67]
    v_mfma_f32_16x16x32_bf16 v[88:91], v[128:131], v[28:31], v[88:91]
    s_waitcnt lgkmcnt(0)
    s_add_u32 s83, s83, 8192
    s_cmp_eq_u32 s83, 81920
    s_cselect_b32 s83, 0, s83
    v_add_u32 v172, s83, v168
    ds_read_b128 v[104:107], v172 offset:0
    v_mfma_f32_16x16x32_bf16 v[36:39], v[156:159], v[136:139], v[36:39]
    ds_read_b128 v[108:111], v172 offset:2048
    v_mov_b32 v22, 2432
    v_mfma_f32_16x16x32_bf16 v[44:47], v[156:159], v[140:143], v[44:47]
    ds_read_b128 v[112:115], v172 offset:4096
    v_cndmask_b32 v205, v23, v22, vcc
    v_mfma_f32_16x16x32_bf16 v[52:55], v[156:159], v[144:147], v[52:55]
    ds_read_b128 v[116:119], v172 offset:6144
    s_mul_i32 s82, s8, 2560
    v_mfma_f32_16x16x32_bf16 v[60:63], v[156:159], v[148:151], v[60:63]
    ds_read_b64_tr_b16 v[124:125], v184 offset:25600
    s_add_u32 s82, s82, 2686976
    v_mfma_f32_16x16x32_bf16 v[84:87], v[156:159], v[28:31], v[84:87]
    ds_read_b64_tr_b16 v[126:127], v184 offset:28160
    v_mfma_f32_16x16x32_bf16 v[40:43], v[160:163], v[136:139], v[40:43]
    ds_read_b64_tr_b16 v[128:129], v185 offset:25600
    v_mfma_f32_16x16x32_bf16 v[48:51], v[160:163], v[140:143], v[48:51]
    ds_read_b64_tr_b16 v[130:131], v185 offset:28160
    v_mfma_f32_16x16x32_bf16 v[56:59], v[160:163], v[144:147], v[56:59]
    v_mfma_f32_16x16x32_bf16 v[64:67], v[160:163], v[148:151], v[64:67]
    v_add_u32 v173, s83, v169
    v_mfma_f32_16x16x32_bf16 v[88:91], v[160:163], v[28:31], v[88:91]
    s_waitcnt lgkmcnt(0)
    ds_read_b128 v[136:139], v173 offset:0
    v_mfma_f32_16x16x32_bf16 v[36:39], v[124:127], v[104:107], v[36:39]
    ds_read_b128 v[140:143], v173 offset:2048
    v_mfma_f32_16x16x32_bf16 v[44:47], v[124:127], v[108:111], v[44:47]
    ds_read_b128 v[144:147], v173 offset:4096
    v_mfma_f32_16x16x32_bf16 v[52:55], v[124:127], v[112:115], v[52:55]
    ds_read_b128 v[148:151], v173 offset:6144
    v_mfma_f32_16x16x32_bf16 v[60:63], v[124:127], v[116:119], v[60:63]
    ds_read_b64_tr_b16 v[156:157], v184 offset:30720
    v_mfma_f32_16x16x32_bf16 v[84:87], v[124:127], v[28:31], v[84:87]
    ds_read_b64_tr_b16 v[158:159], v184 offset:33280
    v_mfma_f32_16x16x32_bf16 v[40:43], v[128:131], v[104:107], v[40:43]
    ds_read_b64_tr_b16 v[160:161], v185 offset:30720
    v_mfma_f32_16x16x32_bf16 v[48:51], v[128:131], v[108:111], v[48:51]
    ds_read_b64_tr_b16 v[162:163], v185 offset:33280
    v_mfma_f32_16x16x32_bf16 v[56:59], v[128:131], v[112:115], v[56:59]
    v_mfma_f32_16x16x32_bf16 v[64:67], v[128:131], v[116:119], v[64:67]
    v_mfma_f32_16x16x32_bf16 v[88:91], v[128:131], v[28:31], v[88:91]
    s_waitcnt lgkmcnt(0)
    s_barrier
    s_add_u32 s83, s83, 8192
    s_cmp_eq_u32 s83, 81920
    s_cselect_b32 s83, 0, s83
    v_add_u32 v172, s83, v168
    ds_read_b128 v[104:107], v172 offset:0
    v_mfma_f32_16x16x32_bf16 v[36:39], v[156:159], v[136:139], v[36:39]
    ds_read_b128 v[108:111], v172 offset:2048
    v_mfma_f32_16x16x32_bf16 v[44:47], v[156:159], v[140:143], v[44:47]
    ds_read_b128 v[112:115], v172 offset:4096
    v_mfma_f32_16x16x32_bf16 v[52:55], v[156:159], v[144:147], v[52:55]
    ds_read_b128 v[116:119], v172 offset:6144
    v_mfma_f32_16x16x32_bf16 v[60:63], v[156:159], v[148:151], v[60:63]
    ds_read_b64_tr_b16 v[124:125], v182 offset:0
    v_mfma_f32_16x16x32_bf16 v[84:87], v[156:159], v[28:31], v[84:87]
    ds_read_b64_tr_b16 v[126:127], v182 offset:2560
    v_mfma_f32_16x16x32_bf16 v[40:43], v[160:163], v[136:139], v[40:43]
    ds_read_b64_tr_b16 v[128:129], v183 offset:0
    v_mfma_f32_16x16x32_bf16 v[48:51], v[160:163], v[140:143], v[48:51]
    ds_read_b64_tr_b16 v[130:131], v183 offset:2560
    v_mfma_f32_16x16x32_bf16 v[56:59], v[160:163], v[144:147], v[56:59]
    v_mfma_f32_16x16x32_bf16 v[64:67], v[160:163], v[148:151], v[64:67]
    v_add_u32 v173, s83, v169
    v_mfma_f32_16x16x32_bf16 v[88:91], v[160:163], v[28:31], v[88:91]
    s_waitcnt lgkmcnt(0)
    ds_read_b128 v[136:139], v173 offset:0
    v_mfma_f32_16x16x32_bf16 v[36:39], v[124:127], v[104:107], v[36:39]
    ds_read_b128 v[140:143], v173 offset:2048
    v_mfma_f32_16x16x32_bf16 v[44:47], v[124:127], v[108:111], v[44:47]
    ds_read_b128 v[144:147], v173 offset:4096
    v_mfma_f32_16x16x32_bf16 v[52:55], v[124:127], v[112:115], v[52:55]
    ds_read_b128 v[148:151], v173 offset:6144
    v_mfma_f32_16x16x32_bf16 v[60:63], v[124:127], v[116:119], v[60:63]
    ds_read_b64_tr_b16 v[156:157], v182 offset:5120
    v_mfma_f32_16x16x32_bf16 v[84:87], v[124:127], v[28:31], v[84:87]
    ds_read_b64_tr_b16 v[158:159], v182 offset:7680
    v_mfma_f32_16x16x32_bf16 v[40:43], v[128:131], v[104:107], v[40:43]
    ds_read_b64_tr_b16 v[160:161], v183 offset:5120
    v_mfma_f32_16x16x32_bf16 v[48:51], v[128:131], v[108:111], v[48:51]
    ds_read_b64_tr_b16 v[162:163], v183 offset:7680
    v_mfma_f32_16x16x32_bf16 v[56:59], v[128:131], v[112:115], v[56:59]
    v_mfma_f32_16x16x32_bf16 v[64:67], v[128:131], v[116:119], v[64:67]
    v_mfma_f32_16x16x32_bf16 v[88:91], v[128:131], v[28:31], v[88:91]
    s_waitcnt lgkmcnt(0)
    s_add_u32 s83, s83, 8192
    s_cmp_eq_u32 s83, 81920
    s_cselect_b32 s83, 0, s83
    v_add_u32 v172, s83, v168
    ds_read_b128 v[104:107], v172 offset:0
    v_mfma_f32_16x16x32_bf16 v[36:39], v[156:159], v[136:139], v[36:39]
    ds_read_b128 v[108:111], v172 offset:2048
    v_mfma_f32_16x16x32_bf16 v[44:47], v[156:159], v[140:143], v[44:47]
    ds_read_b128 v[112:115], v172 offset:4096
    v_mfma_f32_16x16x32_bf16 v[52:55], v[156:159], v[144:147], v[52:55]
    ds_read_b128 v[116:119], v172 offset:6144
    v_mfma_f32_16x16x32_bf16 v[60:63], v[156:159], v[148:151], v[60:63]
    ds_read_b64_tr_b16 v[124:125], v182 offset:10240
    v_mfma_f32_16x16x32_bf16 v[84:87], v[156:159], v[28:31], v[84:87]
    ds_read_b64_tr_b16 v[126:127], v182 offset:12800
    v_mfma_f32_16x16x32_bf16 v[40:43], v[160:163], v[136:139], v[40:43]
    ds_read_b64_tr_b16 v[128:129], v183 offset:10240
    v_mfma_f32_16x16x32_bf16 v[48:51], v[160:163], v[140:143], v[48:51]
    ds_read_b64_tr_b16 v[130:131], v183 offset:12800
    v_mfma_f32_16x16x32_bf16 v[56:59], v[160:163], v[144:147], v[56:59]
    v_mfma_f32_16x16x32_bf16 v[64:67], v[160:163], v[148:151], v[64:67]
    v_add_u32 v173, s83, v169
    v_mfma_f32_16x16x32_bf16 v[88:91], v[160:163], v[28:31], v[88:91]
    s_waitcnt lgkmcnt(0)
    ds_read_b128 v[136:139], v173 offset:0
    v_mfma_f32_16x16x32_bf16 v[36:39], v[124:127], v[104:107], v[36:39]
    ds_read_b128 v[140:143], v173 offset:2048
    v_mfma_f32_16x16x32_bf16 v[44:47], v[124:127], v[108:111], v[44:47]
    ds_read_b128 v[144:147], v173 offset:4096
    v_mfma_f32_16x16x32_bf16 v[52:55], v[124:127], v[112:115], v[52:55]
    ds_read_b128 v[148:151], v173 offset:6144
    v_mfma_f32_16x16x32_bf16 v[60:63], v[124:127], v[116:119], v[60:63]
    ds_read_b64_tr_b16 v[156:157], v182 offset:15360
    v_mfma_f32_16x16x32_bf16 v[84:87], v[124:127], v[28:31], v[84:87]
    ds_read_b64_tr_b16 v[158:159], v182 offset:17920
    v_mfma_f32_16x16x32_bf16 v[40:43], v[128:131], v[104:107], v[40:43]
    ds_read_b64_tr_b16 v[160:161], v183 offset:15360
    v_mfma_f32_16x16x32_bf16 v[48:51], v[128:131], v[108:111], v[48:51]
    ds_read_b64_tr_b16 v[162:163], v183 offset:17920
    v_mfma_f32_16x16x32_bf16 v[56:59], v[128:131], v[112:115], v[56:59]
    v_mfma_f32_16x16x32_bf16 v[64:67], v[128:131], v[116:119], v[64:67]
    v_mfma_f32_16x16x32_bf16 v[88:91], v[128:131], v[28:31], v[88:91]
    s_waitcnt lgkmcnt(0)
    s_add_u32 s83, s83, 8192
    s_cmp_eq_u32 s83, 81920
    s_cselect_b32 s83, 0, s83
    v_add_u32 v172, s83, v168
    ds_read_b128 v[104:107], v172 offset:0
    v_mfma_f32_16x16x32_bf16 v[36:39], v[156:159], v[136:139], v[36:39]
    ds_read_b128 v[108:111], v172 offset:2048
    v_mfma_f32_16x16x32_bf16 v[44:47], v[156:159], v[140:143], v[44:47]
    ds_read_b128 v[112:115], v172 offset:4096
    v_mfma_f32_16x16x32_bf16 v[52:55], v[156:159], v[144:147], v[52:55]
    ds_read_b128 v[116:119], v172 offset:6144
    v_mfma_f32_16x16x32_bf16 v[60:63], v[156:159], v[148:151], v[60:63]
    ds_read_b64_tr_b16 v[124:125], v182 offset:20480
    v_mfma_f32_16x16x32_bf16 v[84:87], v[156:159], v[28:31], v[84:87]
    ds_read_b64_tr_b16 v[126:127], v182 offset:23040
    v_mfma_f32_16x16x32_bf16 v[40:43], v[160:163], v[136:139], v[40:43]
    ds_read_b64_tr_b16 v[128:129], v183 offset:20480
    v_mfma_f32_16x16x32_bf16 v[48:51], v[160:163], v[140:143], v[48:51]
    ds_read_b64_tr_b16 v[130:131], v183 offset:23040
    v_mfma_f32_16x16x32_bf16 v[56:59], v[160:163], v[144:147], v[56:59]
    v_mfma_f32_16x16x32_bf16 v[64:67], v[160:163], v[148:151], v[64:67]
    v_add_u32 v173, s83, v169
    v_mfma_f32_16x16x32_bf16 v[88:91], v[160:163], v[28:31], v[88:91]
    s_waitcnt lgkmcnt(0)
    ds_read_b128 v[136:139], v173 offset:0
    v_mfma_f32_16x16x32_bf16 v[36:39], v[124:127], v[104:107], v[36:39]
    ds_read_b128 v[140:143], v173 offset:2048
    v_mfma_f32_16x16x32_bf16 v[44:47], v[124:127], v[108:111], v[44:47]
    ds_read_b128 v[144:147], v173 offset:4096
    v_mfma_f32_16x16x32_bf16 v[52:55], v[124:127], v[112:115], v[52:55]
    ds_read_b128 v[148:151], v173 offset:6144
    v_mfma_f32_16x16x32_bf16 v[60:63], v[124:127], v[116:119], v[60:63]
    ds_read_b64_tr_b16 v[156:157], v182 offset:25600
    v_mfma_f32_16x16x32_bf16 v[84:87], v[124:127], v[28:31], v[84:87]
    ds_read_b64_tr_b16 v[158:159], v182 offset:28160
    v_mfma_f32_16x16x32_bf16 v[40:43], v[128:131], v[104:107], v[40:43]
    ds_read_b64_tr_b16 v[160:161], v183 offset:25600
    v_mfma_f32_16x16x32_bf16 v[48:51], v[128:131], v[108:111], v[48:51]
    ds_read_b64_tr_b16 v[162:163], v183 offset:28160
    v_mfma_f32_16x16x32_bf16 v[56:59], v[128:131], v[112:115], v[56:59]
    v_mfma_f32_16x16x32_bf16 v[64:67], v[128:131], v[116:119], v[64:67]
    v_mfma_f32_16x16x32_bf16 v[88:91], v[128:131], v[28:31], v[88:91]
    s_waitcnt lgkmcnt(0)
    ds_read_b32 v212, v211 offset:0
    v_mfma_f32_16x16x32_bf16 v[36:39], v[156:159], v[136:139], v[36:39]
    ds_read_b32 v216, v211 offset:256
    v_mfma_f32_16x16x32_bf16 v[44:47], v[156:159], v[140:143], v[44:47]
    ds_read_b32 v213, v211 offset:64
    v_mfma_f32_16x16x32_bf16 v[52:55], v[156:159], v[144:147], v[52:55]
    ds_read_b32 v217, v211 offset:320
    v_mfma_f32_16x16x32_bf16 v[60:63], v[156:159], v[148:151], v[60:63]
    ds_read_b32 v214, v211 offset:128
    v_mfma_f32_16x16x32_bf16 v[84:87], v[156:159], v[28:31], v[84:87]
    ds_read_b32 v218, v211 offset:384
    v_mfma_f32_16x16x32_bf16 v[40:43], v[160:163], v[136:139], v[40:43]
    ds_read_b32 v215, v211 offset:192
    v_mfma_f32_16x16x32_bf16 v[48:51], v[160:163], v[140:143], v[48:51]
    ds_read_b32 v219, v211 offset:448
    v_mfma_f32_16x16x32_bf16 v[56:59], v[160:163], v[144:147], v[56:59]
    ds_read_b64 v[8:9], v206
    v_mfma_f32_16x16x32_bf16 v[64:67], v[160:163], v[148:151], v[64:67]
    ds_read_b64 v[10:11], v207
    v_mfma_f32_16x16x32_bf16 v[88:91], v[160:163], v[28:31], v[88:91]
    ds_read_b64 v[12:13], v208
    ds_read_b64 v[14:15], v209
    ds_read_b64 v[16:17], v210
    s_waitcnt lgkmcnt(0)
    s_barrier
    buffer_load_dwordx4 v[104:107], v200, s[60:63], s82 offen sc1
    buffer_load_dwordx4 v[108:111], v201, s[60:63], s82 offen sc1
    buffer_load_dwordx4 v[112:115], v202, s[60:63], s82 offen sc1
    buffer_load_dwordx4 v[116:119], v203, s[60:63], s82 offen sc1
    buffer_load_dwordx4 v[120:123], v204, s[60:63], s82 offen sc1
    buffer_load_dwordx4 v[124:127], v205, s[60:63], s82 offen sc1
    v_mov_b32 v92, 0x358637bd
    v_mov_b32 v93, 0x358637bd
    v_mov_b32 v94, 0x3fb8aa3b
    v_mov_b32 v95, 0x3fb8aa3b
    s_mov_b32 s12, 0x358637bd
    v_pk_fma_f32 v[20:21], v[216:217], v[84:85], v[92:93] op_sel:[0,0,0] op_sel_hi:[0,1,1] neg_lo:[1,0,0] neg_hi:[1,0,0]
    v_pk_fma_f32 v[36:37], v[36:37], v[212:213], v[20:21] op_sel:[0,0,0] op_sel_hi:[1,0,1]
    v_pk_fma_f32 v[22:23], v[216:217], v[86:87], v[92:93] op_sel:[0,0,0] op_sel_hi:[0,1,1] neg_lo:[1,0,0] neg_hi:[1,0,0]
    v_pk_fma_f32 v[38:39], v[38:39], v[212:213], v[22:23] op_sel:[0,0,0] op_sel_hi:[1,0,1]
    v_pk_fma_f32 v[24:25], v[216:217], v[88:89], v[92:93] op_sel:[0,0,0] op_sel_hi:[0,1,1] neg_lo:[1,0,0] neg_hi:[1,0,0]
    v_pk_fma_f32 v[40:41], v[40:41], v[212:213], v[24:25] op_sel:[0,0,0] op_sel_hi:[1,0,1]
    v_pk_fma_f32 v[26:27], v[216:217], v[90:91], v[92:93] op_sel:[0,0,0] op_sel_hi:[0,1,1] neg_lo:[1,0,0] neg_hi:[1,0,0]
    v_pk_fma_f32 v[42:43], v[42:43], v[212:213], v[26:27] op_sel:[0,0,0] op_sel_hi:[1,0,1]
    v_pk_mul_f32 v[136:137], v[36:37], v[94:95]
    v_pk_mul_f32 v[138:139], v[38:39], v[94:95]
    v_pk_mul_f32 v[140:141], v[40:41], v[94:95]
    v_pk_mul_f32 v[142:143], v[42:43], v[94:95]
    v_exp_f32_e64 v136, v136 clamp
    v_exp_f32_e64 v137, v137 clamp
    v_exp_f32_e64 v138, v138 clamp
    v_exp_f32_e64 v139, v139 clamp
    v_exp_f32_e64 v140, v140 clamp
    v_exp_f32_e64 v141, v141 clamp
    v_exp_f32_e64 v142, v142 clamp
    v_exp_f32_e64 v143, v143 clamp
    v_max_f32 v144, s12, v36
    v_max_f32 v145, s12, v37
    v_max_f32 v146, s12, v38
    v_max_f32 v147, s12, v39
    v_max_f32 v148, s12, v40
    v_max_f32 v149, s12, v41
    v_max_f32 v150, s12, v42
    v_max_f32 v151, s12, v43
    v_pk_add_f32 v[36:37], v[136:137], v[144:145]
    v_pk_add_f32 v[38:39], v[138:139], v[146:147]
    v_pk_add_f32 v[40:41], v[140:141], v[148:149]
    v_pk_add_f32 v[42:43], v[142:143], v[150:151]
    v_cvt_pk_bf16_f32 v220, v36, v37
    v_cvt_pk_bf16_f32 v221, v38, v39
    v_cvt_pk_bf16_f32 v222, v40, v41
    v_cvt_pk_bf16_f32 v223, v42, v43
    v_pk_fma_f32 v[20:21], v[216:217], v[84:85], v[92:93] op_sel:[1,0,0] op_sel_hi:[1,1,1] neg_lo:[1,0,0] neg_hi:[1,0,0]
    v_pk_fma_f32 v[44:45], v[44:45], v[212:213], v[20:21] op_sel:[0,1,0] op_sel_hi:[1,1,1]
    v_pk_fma_f32 v[22:23], v[216:217], v[86:87], v[92:93] op_sel:[1,0,0] op_sel_hi:[1,1,1] neg_lo:[1,0,0] neg_hi:[1,0,0]
    v_pk_fma_f32 v[46:47], v[46:47], v[212:213], v[22:23] op_sel:[0,1,0] op_sel_hi:[1,1,1]
    v_pk_fma_f32 v[24:25], v[216:217], v[88:89], v[92:93] op_sel:[1,0,0] op_sel_hi:[1,1,1] neg_lo:[1,0,0] neg_hi:[1,0,0]
    v_pk_fma_f32 v[48:49], v[48:49], v[212:213], v[24:25] op_sel:[0,1,0] op_sel_hi:[1,1,1]
    v_pk_fma_f32 v[26:27], v[216:217], v[90:91], v[92:93] op_sel:[1,0,0] op_sel_hi:[1,1,1] neg_lo:[1,0,0] neg_hi:[1,0,0]
    v_pk_fma_f32 v[50:51], v[50:51], v[212:213], v[26:27] op_sel:[0,1,0] op_sel_hi:[1,1,1]
    v_pk_mul_f32 v[136:137], v[44:45], v[94:95]
    v_pk_mul_f32 v[138:139], v[46:47], v[94:95]
    v_pk_mul_f32 v[140:141], v[48:49], v[94:95]
    v_pk_mul_f32 v[142:143], v[50:51], v[94:95]
    v_exp_f32_e64 v136, v136 clamp
    v_exp_f32_e64 v137, v137 clamp
    v_exp_f32_e64 v138, v138 clamp
    v_exp_f32_e64 v139, v139 clamp
    v_exp_f32_e64 v140, v140 clamp
    v_exp_f32_e64 v141, v141 clamp
    v_exp_f32_e64 v142, v142 clamp
    v_exp_f32_e64 v143, v143 clamp
    v_max_f32 v144, s12, v44
    v_max_f32 v145, s12, v45
    v_max_f32 v146, s12, v46
    v_max_f32 v147, s12, v47
    v_max_f32 v148, s12, v48
    v_max_f32 v149, s12, v49
    v_max_f32 v150, s12, v50
    v_max_f32 v151, s12, v51
    v_pk_add_f32 v[44:45], v[136:137], v[144:145]
    v_pk_add_f32 v[46:47], v[138:139], v[146:147]
    v_pk_add_f32 v[48:49], v[140:141], v[148:149]
    v_pk_add_f32 v[50:51], v[142:143], v[150:151]
    v_cvt_pk_bf16_f32 v224, v44, v45
    v_cvt_pk_bf16_f32 v225, v46, v47
    v_cvt_pk_bf16_f32 v226, v48, v49
    v_cvt_pk_bf16_f32 v227, v50, v51
    v_pk_fma_f32 v[20:21], v[218:219], v[84:85], v[92:93] op_sel:[0,0,0] op_sel_hi:[0,1,1] neg_lo:[1,0,0] neg_hi:[1,0,0]
    v_pk_fma_f32 v[52:53], v[52:53], v[214:215], v[20:21] op_sel:[0,0,0] op_sel_hi:[1,0,1]
    v_pk_fma_f32 v[22:23], v[218:219], v[86:87], v[92:93] op_sel:[0,0,0] op_sel_hi:[0,1,1] neg_lo:[1,0,0] neg_hi:[1,0,0]
    v_pk_fma_f32 v[54:55], v[54:55], v[214:215], v[22:23] op_sel:[0,0,0] op_sel_hi:[1,0,1]
    v_pk_fma_f32 v[24:25], v[218:219], v[88:89], v[92:93] op_sel:[0,0,0] op_sel_hi:[0,1,1] neg_lo:[1,0,0] neg_hi:[1,0,0]
    v_pk_fma_f32 v[56:57], v[56:57], v[214:215], v[24:25] op_sel:[0,0,0] op_sel_hi:[1,0,1]
    v_pk_fma_f32 v[26:27], v[218:219], v[90:91], v[92:93] op_sel:[0,0,0] op_sel_hi:[0,1,1] neg_lo:[1,0,0] neg_hi:[1,0,0]
    v_pk_fma_f32 v[58:59], v[58:59], v[214:215], v[26:27] op_sel:[0,0,0] op_sel_hi:[1,0,1]
    v_pk_mul_f32 v[136:137], v[52:53], v[94:95]
    v_pk_mul_f32 v[138:139], v[54:55], v[94:95]
    v_pk_mul_f32 v[140:141], v[56:57], v[94:95]
    v_pk_mul_f32 v[142:143], v[58:59], v[94:95]
    v_exp_f32_e64 v136, v136 clamp
    v_exp_f32_e64 v137, v137 clamp
    v_exp_f32_e64 v138, v138 clamp
    v_exp_f32_e64 v139, v139 clamp
    v_exp_f32_e64 v140, v140 clamp
    v_exp_f32_e64 v141, v141 clamp
    v_exp_f32_e64 v142, v142 clamp
    v_exp_f32_e64 v143, v143 clamp
    v_max_f32 v144, s12, v52
    v_max_f32 v145, s12, v53
    v_max_f32 v146, s12, v54
    v_max_f32 v147, s12, v55
    v_max_f32 v148, s12, v56
    v_max_f32 v149, s12, v57
    v_max_f32 v150, s12, v58
    v_max_f32 v151, s12, v59
    v_pk_add_f32 v[52:53], v[136:137], v[144:145]
    v_pk_add_f32 v[54:55], v[138:139], v[146:147]
    v_pk_add_f32 v[56:57], v[140:141], v[148:149]
    v_pk_add_f32 v[58:59], v[142:143], v[150:151]
    v_cvt_pk_bf16_f32 v228, v52, v53
    v_cvt_pk_bf16_f32 v229, v54, v55
    v_cvt_pk_bf16_f32 v230, v56, v57
    v_cvt_pk_bf16_f32 v231, v58, v59
    v_pk_fma_f32 v[20:21], v[218:219], v[84:85], v[92:93] op_sel:[1,0,0] op_sel_hi:[1,1,1] neg_lo:[1,0,0] neg_hi:[1,0,0]
    v_pk_fma_f32 v[60:61], v[60:61], v[214:215], v[20:21] op_sel:[0,1,0] op_sel_hi:[1,1,1]
    v_pk_fma_f32 v[22:23], v[218:219], v[86:87], v[92:93] op_sel:[1,0,0] op_sel_hi:[1,1,1] neg_lo:[1,0,0] neg_hi:[1,0,0]
    v_pk_fma_f32 v[62:63], v[62:63], v[214:215], v[22:23] op_sel:[0,1,0] op_sel_hi:[1,1,1]
    v_pk_fma_f32 v[24:25], v[218:219], v[88:89], v[92:93] op_sel:[1,0,0] op_sel_hi:[1,1,1] neg_lo:[1,0,0] neg_hi:[1,0,0]
    v_pk_fma_f32 v[64:65], v[64:65], v[214:215], v[24:25] op_sel:[0,1,0] op_sel_hi:[1,1,1]
    v_pk_fma_f32 v[26:27], v[218:219], v[90:91], v[92:93] op_sel:[1,0,0] op_sel_hi:[1,1,1] neg_lo:[1,0,0] neg_hi:[1,0,0]
    v_pk_fma_f32 v[66:67], v[66:67], v[214:215], v[26:27] op_sel:[0,1,0] op_sel_hi:[1,1,1]
    v_pk_mul_f32 v[136:137], v[60:61], v[94:95]
    v_pk_mul_f32 v[138:139], v[62:63], v[94:95]
    v_pk_mul_f32 v[140:141], v[64:65], v[94:95]
    v_pk_mul_f32 v[142:143], v[66:67], v[94:95]
    v_exp_f32_e64 v136, v136 clamp
    v_exp_f32_e64 v137, v137 clamp
    v_exp_f32_e64 v138, v138 clamp
    v_exp_f32_e64 v139, v139 clamp
    v_exp_f32_e64 v140, v140 clamp
    v_exp_f32_e64 v141, v141 clamp
    v_exp_f32_e64 v142, v142 clamp
    v_exp_f32_e64 v143, v143 clamp
    v_max_f32 v144, s12, v60
    v_max_f32 v145, s12, v61
    v_max_f32 v146, s12, v62
    v_max_f32 v147, s12, v63
    v_max_f32 v148, s12, v64
    v_max_f32 v149, s12, v65
    v_max_f32 v150, s12, v66
    v_max_f32 v151, s12, v67
    v_pk_add_f32 v[60:61], v[136:137], v[144:145]
    v_pk_add_f32 v[62:63], v[138:139], v[146:147]
    v_pk_add_f32 v[64:65], v[140:141], v[148:149]
    v_pk_add_f32 v[66:67], v[142:143], v[150:151]
    v_cvt_pk_bf16_f32 v232, v60, v61
    v_cvt_pk_bf16_f32 v233, v62, v63
    v_cvt_pk_bf16_f32 v234, v64, v65
    v_cvt_pk_bf16_f32 v235, v66, v67
    s_mov_b32 s78, 0
    s_branch L_gchk_7
L_gsp_5:
    buffer_load_dwordx4 v[104:107], v200, s[60:63], s82 offen sc1
    buffer_load_dwordx4 v[108:111], v201, s[60:63], s82 offen sc1
    buffer_load_dwordx4 v[112:115], v202, s[60:63], s82 offen sc1
    buffer_load_dwordx4 v[116:119], v203, s[60:63], s82 offen sc1
    buffer_load_dwordx4 v[120:123], v204, s[60:63], s82 offen sc1
    buffer_load_dwordx4 v[124:127], v205, s[60:63], s82 offen sc1
L_gchk_7:
    s_waitcnt vmcnt(0)
    s_lshl_b32 s98, s7, 16
    s_mov_b32 s99, 0xffff0000
    v_mov_b32 v20, 0
    v_xor_b32 v22, s98, v105
    v_xor_b32 v23, s98, v107
    v_or3_b32 v20, v20, v22, v23
    v_xor_b32 v22, s98, v113
    v_xor_b32 v23, s98, v115
    v_or3_b32 v20, v20, v22, v23
    v_xor_b32 v22, s98, v121
    v_xor_b32 v23, s98, v123
    v_or3_b32 v20, v20, v22, v23
    s_mov_b64 exec, 0xffff
    v_xor_b32 v22, s98, v109
    v_xor_b32 v23, s98, v111
    v_or3_b32 v20, v20, v22, v23
    v_xor_b32 v22, s98, v117
    v_xor_b32 v23, s98, v119
    v_or3_b32 v20, v20, v22, v23
    v_xor_b32 v22, s98, v125
    v_xor_b32 v23, s98, v127
    v_or3_b32 v20, v20, v22, v23
    s_mov_b64 exec, -1
    v_and_b32 v20, s99, v20
    v_cmp_ne_u32 vcc, 0, v20
    s_add_u32 s78, s78, 1
    s_cmp_gt_u32 s78, 200000
    s_cbranch_scc1 L_gdn_6
    s_nop 1
    s_cbranch_vccz L_gdn_6
    s_sleep 1
    s_branch L_gsp_5
L_gdn_6:
    s_mov_b32 s96, 0x0201000c
    s_mov_b32 s97, 0x0504030c
    v_perm_b32 v136, v104, v104, s96
    v_perm_b32 v137, v105, v104, s97
    v_perm_b32 v138, v106, v106, s96
    v_perm_b32 v139, v107, v106, s97
    v_cvt_pk_bf16_f32 v188, v136, v137
    v_cvt_pk_bf16_f32 v189, v138, v139
    v_perm_b32 v140, v108, v108, s96
    v_perm_b32 v141, v109, v108, s97
    v_perm_b32 v142, v110, v110, s96
    v_perm_b32 v143, v111, v110, s97
    v_cvt_pk_bf16_f32 v190, v140, v141
    v_cvt_pk_bf16_f32 v191, v142, v143
    v_perm_b32 v136, v112, v112, s96
    v_perm_b32 v137, v113, v112, s97
    v_perm_b32 v138, v114, v114, s96
    v_perm_b32 v139, v115, v114, s97
    v_cvt_pk_bf16_f32 v192, v136, v137
    v_cvt_pk_bf16_f32 v193, v138, v139
    v_perm_b32 v140, v116, v116, s96
    v_perm_b32 v141, v117, v116, s97
    v_perm_b32 v142, v118, v118, s96
    v_perm_b32 v143, v119, v118, s97
    v_cvt_pk_bf16_f32 v194, v140, v141
    v_cvt_pk_bf16_f32 v195, v142, v143
    v_perm_b32 v136, v120, v120, s96
    v_perm_b32 v137, v121, v120, s97
    v_perm_b32 v138, v122, v122, s96
    v_perm_b32 v139, v123, v122, s97
    v_cvt_pk_bf16_f32 v196, v136, v137
    v_cvt_pk_bf16_f32 v197, v138, v139
    v_perm_b32 v140, v124, v124, s96
    v_perm_b32 v141, v125, v124, s97
    v_perm_b32 v142, v126, v126, s96
    v_perm_b32 v143, v127, v126, s97
    v_cvt_pk_bf16_f32 v198, v140, v141
    v_cvt_pk_bf16_f32 v199, v142, v143
    s_nop 1
    v_mfma_f32_16x16x32_bf16 v[44:47], v[196:199], v[220:223], 0
    v_mfma_f32_16x16x32_bf16 v[36:39], v[188:191], v[220:223], 0
    v_mfma_f32_16x16x32_bf16 v[40:43], v[192:195], v[220:223], 0
    v_mfma_f32_16x16x32_bf16 v[56:59], v[196:199], v[224:227], 0
    v_mfma_f32_16x16x32_bf16 v[48:51], v[188:191], v[224:227], 0
    v_mfma_f32_16x16x32_bf16 v[52:55], v[192:195], v[224:227], 0
    v_mfma_f32_16x16x32_bf16 v[68:71], v[196:199], v[228:231], 0
    v_mfma_f32_16x16x32_bf16 v[60:63], v[188:191], v[228:231], 0
    v_mfma_f32_16x16x32_bf16 v[64:67], v[192:195], v[228:231], 0
    v_mfma_f32_16x16x32_bf16 v[80:83], v[196:199], v[232:235], 0
    v_mfma_f32_16x16x32_bf16 v[72:75], v[188:191], v[232:235], 0
    v_mfma_f32_16x16x32_bf16 v[76:79], v[192:195], v[232:235], 0
    s_lshr_b32 s10, s9, 1
    s_lshl_b32 s10, s10, 10
    s_and_b32 s11, s9, 1
    s_lshl_b32 s11, s11, 3
    s_add_u32 s10, s10, s11
    s_add_u32 s10, s10, 106496
    v_add_u32 v104, s10, v3
    s_lshl_b32 s10, s9, 7
    s_add_u32 s10, s10, 108544
    v_add_u32 v105, s10, v6
    v_add_f32 v20, 0x358637bd, v44
    v_rcp_f32 v20, v20
    s_nop 0
    v_pk_mul_f32 v[36:37], v[36:37], v[20:21] op_sel_hi:[1,0]
    v_pk_mul_f32 v[38:39], v[38:39], v[20:21] op_sel_hi:[1,0]
    v_pk_mul_f32 v[40:41], v[40:41], v[20:21] op_sel_hi:[1,0]
    v_pk_mul_f32 v[42:43], v[42:43], v[20:21] op_sel_hi:[1,0]
    v_cvt_pk_bf16_f32 v36, v36, v37
    v_cvt_pk_bf16_f32 v37, v38, v39
    v_cvt_pk_bf16_f32 v40, v40, v41
    v_cvt_pk_bf16_f32 v41, v42, v43
    ds_write_b64 v104, v[36:37] offset:0
    s_mov_b64 exec, 0xffff
    ds_write_b64 v105, v[40:41] offset:0
    s_mov_b64 exec, -1
    v_add_f32 v20, 0x358637bd, v56
    v_rcp_f32 v20, v20
    s_nop 0
    v_pk_mul_f32 v[48:49], v[48:49], v[20:21] op_sel_hi:[1,0]
    v_pk_mul_f32 v[50:51], v[50:51], v[20:21] op_sel_hi:[1,0]
    v_pk_mul_f32 v[52:53], v[52:53], v[20:21] op_sel_hi:[1,0]
    v_pk_mul_f32 v[54:55], v[54:55], v[20:21] op_sel_hi:[1,0]
    v_cvt_pk_bf16_f32 v48, v48, v49
    v_cvt_pk_bf16_f32 v49, v50, v51
    v_cvt_pk_bf16_f32 v52, v52, v53
    v_cvt_pk_bf16_f32 v53, v54, v55
    ds_write_b64 v104, v[48:49] offset:2560
    s_mov_b64 exec, 0xffff
    ds_write_b64 v105, v[52:53] offset:2560
    s_mov_b64 exec, -1
    v_add_f32 v20, 0x358637bd, v68
    v_rcp_f32 v20, v20
    s_nop 0
    v_pk_mul_f32 v[60:61], v[60:61], v[20:21] op_sel_hi:[1,0]
    v_pk_mul_f32 v[62:63], v[62:63], v[20:21] op_sel_hi:[1,0]
    v_pk_mul_f32 v[64:65], v[64:65], v[20:21] op_sel_hi:[1,0]
    v_pk_mul_f32 v[66:67], v[66:67], v[20:21] op_sel_hi:[1,0]
    v_cvt_pk_bf16_f32 v60, v60, v61
    v_cvt_pk_bf16_f32 v61, v62, v63
    v_cvt_pk_bf16_f32 v64, v64, v65
    v_cvt_pk_bf16_f32 v65, v66, v67
    ds_write_b64 v104, v[60:61] offset:5120
    s_mov_b64 exec, 0xffff
    ds_write_b64 v105, v[64:65] offset:5120
    s_mov_b64 exec, -1
    v_add_f32 v20, 0x358637bd, v80
    v_rcp_f32 v20, v20
    s_nop 0
    v_pk_mul_f32 v[72:73], v[72:73], v[20:21] op_sel_hi:[1,0]
    v_pk_mul_f32 v[74:75], v[74:75], v[20:21] op_sel_hi:[1,0]
    v_pk_mul_f32 v[76:77], v[76:77], v[20:21] op_sel_hi:[1,0]
    v_pk_mul_f32 v[78:79], v[78:79], v[20:21] op_sel_hi:[1,0]
    v_cvt_pk_bf16_f32 v72, v72, v73
    v_cvt_pk_bf16_f32 v73, v74, v75
    v_cvt_pk_bf16_f32 v76, v76, v77
    v_cvt_pk_bf16_f32 v77, v78, v79
    ds_write_b64 v104, v[72:73] offset:7680
    s_mov_b64 exec, 0xffff
    ds_write_b64 v105, v[76:77] offset:7680
    s_mov_b64 exec, -1
    v_mov_b32 v20, 156192
    v_mov_b32 v21, 1
    s_waitcnt lgkmcnt(0)
    s_mov_b64 exec, 1
    ds_add_u32 v20, v21
    s_mov_b64 exec, -1
    s_mov_b32 s78, 0
L_ox_8:
    ds_read_b32 v21, v20
    s_waitcnt lgkmcnt(0)
    v_readfirstlane_b32 s10, v21
    s_add_u32 s78, s78, 1
    s_cmp_gt_u32 s78, 1600000
    s_cbranch_scc1 L_oxe_9
    s_cmp_lt_u32 s10, 4
    s_cbranch_scc1 L_ox_8
L_oxe_9:
    s_mul_i32 s10, s9, 2560
    s_add_u32 s10, s10, 106496
    v_add_u32 v104, s10, v3
    v_add_u32 v105, s10, v6
    ds_read_b128 v[108:111], v104
    ds_read_b128 v[112:115], v104 offset:1024
    ds_read_b64 v[116:117], v105 offset:2048
    s_lshl_b32 s10, s5, 2
    s_add_u32 s10, s10, s9
    s_mul_i32 s10, s10, 20480
    s_add_u32 s10, s10, 3145728
    s_lshl_b32 s12, s6, 11
    s_add_u32 s12, s12, s10
    s_lshr_b32 s13, s6, 1
    s_add_u32 s13, s13, 16
    s_lshl_b32 s13, s13, 10
    s_and_b32 s14, s6, 1
    s_lshl_b32 s14, s14, 9
    s_add_u32 s13, s13, s14
    s_add_u32 s13, s13, s10
    s_waitcnt lgkmcnt(0)
    buffer_store_dwordx4 v[108:111], v3, s[60:63], s12 offen sc1
    buffer_store_dwordx4 v[112:115], v3, s[60:63], s12 offen offset:1024 sc1
    buffer_store_dwordx2 v[116:117], v6, s[60:63], s13 offen sc1
    v_add_u32 v196, 0, v7
    v_add_u32 v197, 51200, v7
    v_add_u32 v20, 1, v2
    v_mul_u32_u24 v20, 2560, v20
    v_add_u32 v198, v20, v196
    v_add_u32 v199, v20, v197
    v_mov_b32 v116, 0
    v_mov_b32 v117, 0
    v_mov_b32 v118, 0
    v_mov_b32 v119, 0
    v_mov_b32 v120, 0
    v_mov_b32 v121, 0
    v_mov_b32 v122, 0
    v_mov_b32 v123, 0
    v_mov_b32 v124, 0
    v_mov_b32 v125, 0
    v_mov_b32 v126, 0
    v_mov_b32 v127, 0
    v_mov_b32 v128, 0
    v_mov_b32 v129, 0
    v_mov_b32 v130, 0
    v_mov_b32 v131, 0
    v_mov_b32 v132, 0
    v_mov_b32 v133, 0
    v_mov_b32 v134, 0
    v_mov_b32 v135, 0
    v_mov_b32 v20, 156160
    v_mov_b32 v21, 1
    s_waitcnt vmcnt(0)
    s_mov_b64 exec, 1
    ds_add_rtn_u32 v22, v20, v21
    s_mov_b64 exec, -1
    s_waitcnt lgkmcnt(0)
    v_readfirstlane_b32 s10, v22
    s_nop 3
    s_cmp_lg_u32 s10, 3
    s_cbranch_scc1 L_pub_10
    s_lshl_b32 s10, s5, 7
    s_lshl_b32 s11, s6, 2
    s_add_u32 s10, s10, s11
    s_add_u32 s10, s10, 12288
    v_mov_b32 v20, s7
    s_mov_b64 exec, 1
    buffer_store_dword v20, v4, s[60:63], s10 offen sc1
    s_mov_b64 exec, -1
L_pub_10:
    s_lshl_b32 s79, s5, 2
    s_add_u32 s79, s79, s9
    s_mul_i32 s79, s79, 20480
    s_add_u32 s79, s79, 3145728
    v_mov_b32 v20, 156176
    s_cmp_lg_u32 s9, 0
    s_cbranch_scc1 L_shf_11
    s_lshl_b32 s10, s5, 7
    s_add_u32 s10, s10, 12288
    s_add_u32 s100, s36, s10
    s_addc_u32 s101, s37, 0
    s_mov_b32 s78, 0
L_sq_15:
    s_load_dwordx8 s[64:71], s[100:101], 0 glc
    s_waitcnt lgkmcnt(0)
    s_xor_b32 s10, s64, s7
    s_xor_b32 s11, s65, s7
    s_or_b32 s10, s10, s11
    s_xor_b32 s11, s66, s7
    s_or_b32 s10, s10, s11
    s_xor_b32 s11, s67, s7
    s_or_b32 s10, s10, s11
    s_xor_b32 s11, s68, s7
    s_or_b32 s10, s10, s11
    s_xor_b32 s11, s69, s7
    s_or_b32 s10, s10, s11
    s_xor_b32 s11, s70, s7
    s_or_b32 s10, s10, s11
    s_xor_b32 s11, s71, s7
    s_or_b32 s10, s10, s11
    s_cmp_eq_u32 s10, 0
    s_cbranch_scc1 L_sqd_16
    s_add_u32 s78, s78, 1
    s_cmp_lt_u32 s78, 200000
    s_cbranch_scc1 L_sq_15
L_sqd_16:
    v_mov_b32 v21, 1
    s_mov_b64 exec, 1
    ds_write_b32 v20, v21
    s_mov_b64 exec, -1
    s_waitcnt lgkmcnt(0)
    s_branch L_she_12
L_shf_11:
    s_mov_b32 s78, 0
L_shl_13:
    ds_read_b32 v21, v20
    s_waitcnt lgkmcnt(0)
    v_readfirstlane_b32 s10, v21
    s_add_u32 s78, s78, 1
    s_cmp_gt_u32 s78, 1600000
    s_cbranch_scc1 L_she_12
    s_cmp_eq_u32 s10, 0
    s_cbranch_scc1 L_shl_13
L_she_12:
    s_or_b32 s10, s2, s4
    s_cmp_lg_u32 s10, 0
    s_cbranch_scc1 L_ep_17
    v_mov_b32 v20, s7
    s_mov_b64 exec, 1
    buffer_store_dword v20, v4, s[60:63], 0 offen sc1
    s_mov_b64 exec, -1
L_ep_17:
    s_mov_b32 s80, s79
    buffer_load_dwordx4 v[36:39], v3, s[60:63], s80 offen offset:0 sc1
    buffer_load_dwordx4 v[40:43], v3, s[60:63], s80 offen offset:1024 sc1
    buffer_load_dwordx4 v[44:47], v3, s[60:63], s80 offen offset:2048 sc1
    buffer_load_dwordx4 v[48:51], v3, s[60:63], s80 offen offset:3072 sc1
    s_add_u32 s80, s80, 4096
    buffer_load_dwordx4 v[52:55], v3, s[60:63], s80 offen offset:0 sc1
    buffer_load_dwordx4 v[56:59], v3, s[60:63], s80 offen offset:1024 sc1
    buffer_load_dwordx4 v[60:63], v3, s[60:63], s80 offen offset:2048 sc1
    buffer_load_dwordx4 v[64:67], v3, s[60:63], s80 offen offset:3072 sc1
    s_add_u32 s80, s80, 4096
    s_barrier
    ds_read_b64_tr_b16 v[136:137], v196 offset:0
    ds_read_b64_tr_b16 v[138:139], v196 offset:3200
    ds_read_b64_tr_b16 v[140:141], v196 offset:32
    ds_read_b64_tr_b16 v[142:143], v196 offset:3232
    ds_read_b64_tr_b16 v[144:145], v196 offset:64
    ds_read_b64_tr_b16 v[146:147], v196 offset:3264
    ds_read_b64_tr_b16 v[148:149], v196 offset:96
    ds_read_b64_tr_b16 v[150:151], v196 offset:3296
    ds_read_b64_tr_b16 v[152:153], v196 offset:128
    ds_read_b64_tr_b16 v[154:155], v196 offset:3328
    ds_read_b64_tr_b16 v[156:157], v196 offset:6400
    ds_read_b64_tr_b16 v[158:159], v196 offset:9600
    ds_read_b64_tr_b16 v[160:161], v196 offset:6432
    ds_read_b64_tr_b16 v[162:163], v196 offset:9632
    ds_read_b64_tr_b16 v[164:165], v196 offset:6464
    ds_read_b64_tr_b16 v[166:167], v196 offset:9664
    ds_read_b64_tr_b16 v[168:169], v196 offset:6496
    ds_read_b64_tr_b16 v[170:171], v196 offset:9696
    ds_read_b64_tr_b16 v[172:173], v196 offset:6528
    ds_read_b64_tr_b16 v[174:175], v196 offset:9728
    s_waitcnt lgkmcnt(10)
    s_waitcnt vmcnt(7)
    v_mfma_f32_16x16x32_bf16 v[116:119], v[136:139], v[36:39], v[116:119]
    ds_read_b64_tr_b16 v[176:177], v196 offset:12800
    ds_read_b64_tr_b16 v[178:179], v196 offset:16000
    v_mfma_f32_16x16x32_bf16 v[120:123], v[140:143], v[36:39], v[120:123]
    ds_read_b64_tr_b16 v[180:181], v196 offset:12832
    ds_read_b64_tr_b16 v[182:183], v196 offset:16032
    buffer_load_dwordx4 v[68:71], v3, s[60:63], s80 offen offset:0 sc1
    v_mfma_f32_16x16x32_bf16 v[124:127], v[144:147], v[36:39], v[124:127]
    ds_read_b64_tr_b16 v[184:185], v196 offset:12864
    ds_read_b64_tr_b16 v[186:187], v196 offset:16064
    v_mfma_f32_16x16x32_bf16 v[128:131], v[148:151], v[36:39], v[128:131]
    ds_read_b64_tr_b16 v[188:189], v196 offset:12896
    ds_read_b64_tr_b16 v[190:191], v196 offset:16096
    v_mfma_f32_16x16x32_bf16 v[132:135], v[152:155], v[36:39], v[132:135]
    ds_read_b64_tr_b16 v[192:193], v196 offset:12928
    ds_read_b64_tr_b16 v[194:195], v196 offset:16128
    s_waitcnt lgkmcnt(10)
    s_waitcnt vmcnt(7)
    v_mfma_f32_16x16x32_bf16 v[116:119], v[156:159], v[40:43], v[116:119]
    ds_read_b64_tr_b16 v[136:137], v196 offset:19200
    ds_read_b64_tr_b16 v[138:139], v196 offset:22400
    v_mfma_f32_16x16x32_bf16 v[120:123], v[160:163], v[40:43], v[120:123]
    ds_read_b64_tr_b16 v[140:141], v196 offset:19232
    ds_read_b64_tr_b16 v[142:143], v196 offset:22432
    buffer_load_dwordx4 v[72:75], v3, s[60:63], s80 offen offset:1024 sc1
    v_mfma_f32_16x16x32_bf16 v[124:127], v[164:167], v[40:43], v[124:127]
    ds_read_b64_tr_b16 v[144:145], v196 offset:19264
    ds_read_b64_tr_b16 v[146:147], v196 offset:22464
    v_mfma_f32_16x16x32_bf16 v[128:131], v[168:171], v[40:43], v[128:131]
    ds_read_b64_tr_b16 v[148:149], v196 offset:19296
    ds_read_b64_tr_b16 v[150:151], v196 offset:22496
    v_mfma_f32_16x16x32_bf16 v[132:135], v[172:175], v[40:43], v[132:135]
    ds_read_b64_tr_b16 v[152:153], v196 offset:19328
    ds_read_b64_tr_b16 v[154:155], v196 offset:22528
    s_waitcnt lgkmcnt(10)
    s_waitcnt vmcnt(7)
    v_mfma_f32_16x16x32_bf16 v[116:119], v[176:179], v[44:47], v[116:119]
    ds_read_b64_tr_b16 v[156:157], v196 offset:25600
    ds_read_b64_tr_b16 v[158:159], v196 offset:28800
    v_mfma_f32_16x16x32_bf16 v[120:123], v[180:183], v[44:47], v[120:123]
    ds_read_b64_tr_b16 v[160:161], v196 offset:25632
    ds_read_b64_tr_b16 v[162:163], v196 offset:28832
    buffer_load_dwordx4 v[76:79], v3, s[60:63], s80 offen offset:2048 sc1
    v_mfma_f32_16x16x32_bf16 v[124:127], v[184:187], v[44:47], v[124:127]
    ds_read_b64_tr_b16 v[164:165], v196 offset:25664
    ds_read_b64_tr_b16 v[166:167], v196 offset:28864
    v_mfma_f32_16x16x32_bf16 v[128:131], v[188:191], v[44:47], v[128:131]
    ds_read_b64_tr_b16 v[168:169], v196 offset:25696
    ds_read_b64_tr_b16 v[170:171], v196 offset:28896
    buffer_load_dwordx4 v[80:83], v3, s[60:63], s80 offen offset:3072 sc1
    s_add_u32 s80, s80, 4096
    v_mfma_f32_16x16x32_bf16 v[132:135], v[192:195], v[44:47], v[132:135]
    ds_read_b64_tr_b16 v[172:173], v196 offset:25728
    ds_read_b64_tr_b16 v[174:175], v196 offset:28928
    s_waitcnt lgkmcnt(10)
    s_waitcnt vmcnt(8)
    v_mfma_f32_16x16x32_bf16 v[116:119], v[136:139], v[48:51], v[116:119]
    ds_read_b64_tr_b16 v[176:177], v196 offset:32000
    ds_read_b64_tr_b16 v[178:179], v196 offset:35200
    v_mfma_f32_16x16x32_bf16 v[120:123], v[140:143], v[48:51], v[120:123]
    ds_read_b64_tr_b16 v[180:181], v196 offset:32032
    ds_read_b64_tr_b16 v[182:183], v196 offset:35232
    buffer_load_dwordx4 v[84:87], v3, s[60:63], s80 offen offset:0 sc1
    v_mfma_f32_16x16x32_bf16 v[124:127], v[144:147], v[48:51], v[124:127]
    ds_read_b64_tr_b16 v[184:185], v196 offset:32064
    ds_read_b64_tr_b16 v[186:187], v196 offset:35264
    v_mfma_f32_16x16x32_bf16 v[128:131], v[148:151], v[48:51], v[128:131]
    ds_read_b64_tr_b16 v[188:189], v196 offset:32096
    ds_read_b64_tr_b16 v[190:191], v196 offset:35296
    buffer_load_dwordx4 v[88:91], v3, s[60:63], s80 offen offset:1024 sc1
    v_mfma_f32_16x16x32_bf16 v[132:135], v[152:155], v[48:51], v[132:135]
    ds_read_b64_tr_b16 v[192:193], v196 offset:32128
    ds_read_b64_tr_b16 v[194:195], v196 offset:35328
    s_waitcnt lgkmcnt(10)
    s_waitcnt vmcnt(9)
    v_mfma_f32_16x16x32_bf16 v[116:119], v[156:159], v[52:55], v[116:119]
    ds_read_b64_tr_b16 v[136:137], v196 offset:38400
    ds_read_b64_tr_b16 v[138:139], v196 offset:41600
    v_mfma_f32_16x16x32_bf16 v[120:123], v[160:163], v[52:55], v[120:123]
    ds_read_b64_tr_b16 v[140:141], v196 offset:38432
    ds_read_b64_tr_b16 v[142:143], v196 offset:41632
    buffer_load_dwordx4 v[92:95], v3, s[60:63], s80 offen offset:2048 sc1
    v_mfma_f32_16x16x32_bf16 v[124:127], v[164:167], v[52:55], v[124:127]
    ds_read_b64_tr_b16 v[144:145], v196 offset:38464
    ds_read_b64_tr_b16 v[146:147], v196 offset:41664
    v_mfma_f32_16x16x32_bf16 v[128:131], v[168:171], v[52:55], v[128:131]
    ds_read_b64_tr_b16 v[148:149], v196 offset:38496
    ds_read_b64_tr_b16 v[150:151], v196 offset:41696
    v_mfma_f32_16x16x32_bf16 v[132:135], v[172:175], v[52:55], v[132:135]
    ds_read_b64_tr_b16 v[152:153], v196 offset:38528
    ds_read_b64_tr_b16 v[154:155], v196 offset:41728
    s_waitcnt lgkmcnt(10)
    s_waitcnt vmcnt(9)
    v_mfma_f32_16x16x32_bf16 v[116:119], v[176:179], v[56:59], v[116:119]
    ds_read_b64_tr_b16 v[156:157], v196 offset:44800
    ds_read_b64_tr_b16 v[158:159], v196 offset:48000
    v_mfma_f32_16x16x32_bf16 v[120:123], v[180:183], v[56:59], v[120:123]
    ds_read_b64_tr_b16 v[160:161], v196 offset:44832
    ds_read_b64_tr_b16 v[162:163], v196 offset:48032
    buffer_load_dwordx4 v[96:99], v3, s[60:63], s80 offen offset:3072 sc1
    s_add_u32 s80, s80, 4096
    v_mfma_f32_16x16x32_bf16 v[124:127], v[184:187], v[56:59], v[124:127]
    ds_read_b64_tr_b16 v[164:165], v196 offset:44864
    ds_read_b64_tr_b16 v[166:167], v196 offset:48064
    v_mfma_f32_16x16x32_bf16 v[128:131], v[188:191], v[56:59], v[128:131]
    ds_read_b64_tr_b16 v[168:169], v196 offset:44896
    ds_read_b64_tr_b16 v[170:171], v196 offset:48096
    v_mfma_f32_16x16x32_bf16 v[132:135], v[192:195], v[56:59], v[132:135]
    ds_read_b64_tr_b16 v[172:173], v196 offset:44928
    ds_read_b64_tr_b16 v[174:175], v196 offset:48128
    s_waitcnt lgkmcnt(10)
    s_waitcnt vmcnt(9)
    v_mfma_f32_16x16x32_bf16 v[116:119], v[136:139], v[60:63], v[116:119]
    ds_read_b64_tr_b16 v[176:177], v197 offset:0
    ds_read_b64_tr_b16 v[178:179], v197 offset:3200
    v_mfma_f32_16x16x32_bf16 v[120:123], v[140:143], v[60:63], v[120:123]
    ds_read_b64_tr_b16 v[180:181], v197 offset:32
    ds_read_b64_tr_b16 v[182:183], v197 offset:3232
    buffer_load_dwordx2 v[100:101], v6, s[60:63], s80 offen offset:0 sc1
    v_mfma_f32_16x16x32_bf16 v[124:127], v[144:147], v[60:63], v[124:127]
    ds_read_b64_tr_b16 v[184:185], v197 offset:64
    ds_read_b64_tr_b16 v[186:187], v197 offset:3264
    v_mfma_f32_16x16x32_bf16 v[128:131], v[148:151], v[60:63], v[128:131]
    ds_read_b64_tr_b16 v[188:189], v197 offset:96
    ds_read_b64_tr_b16 v[190:191], v197 offset:3296
    v_mfma_f32_16x16x32_bf16 v[132:135], v[152:155], v[60:63], v[132:135]
    ds_read_b64_tr_b16 v[192:193], v197 offset:128
    ds_read_b64_tr_b16 v[194:195], v197 offset:3328
    s_waitcnt lgkmcnt(10)
    s_waitcnt vmcnt(9)
    v_mfma_f32_16x16x32_bf16 v[116:119], v[156:159], v[64:67], v[116:119]
    ds_read_b64_tr_b16 v[136:137], v197 offset:6400
    ds_read_b64_tr_b16 v[138:139], v197 offset:9600
    v_mfma_f32_16x16x32_bf16 v[120:123], v[160:163], v[64:67], v[120:123]
    ds_read_b64_tr_b16 v[140:141], v197 offset:6432
    ds_read_b64_tr_b16 v[142:143], v197 offset:9632
    buffer_load_dwordx2 v[102:103], v6, s[60:63], s80 offen offset:512 sc1
    v_mfma_f32_16x16x32_bf16 v[124:127], v[164:167], v[64:67], v[124:127]
    ds_read_b64_tr_b16 v[144:145], v197 offset:6464
    ds_read_b64_tr_b16 v[146:147], v197 offset:9664
    v_mfma_f32_16x16x32_bf16 v[128:131], v[168:171], v[64:67], v[128:131]
    ds_read_b64_tr_b16 v[148:149], v197 offset:6496
    ds_read_b64_tr_b16 v[150:151], v197 offset:9696
    v_mfma_f32_16x16x32_bf16 v[132:135], v[172:175], v[64:67], v[132:135]
    ds_read_b64_tr_b16 v[152:153], v197 offset:6528
    ds_read_b64_tr_b16 v[154:155], v197 offset:9728
    s_waitcnt lgkmcnt(10)
    s_waitcnt vmcnt(9)
    v_mfma_f32_16x16x32_bf16 v[116:119], v[176:179], v[68:71], v[116:119]
    ds_read_b64_tr_b16 v[156:157], v197 offset:12800
    ds_read_b64_tr_b16 v[158:159], v197 offset:16000
    v_mfma_f32_16x16x32_bf16 v[120:123], v[180:183], v[68:71], v[120:123]
    ds_read_b64_tr_b16 v[160:161], v197 offset:12832
    ds_read_b64_tr_b16 v[162:163], v197 offset:16032
    buffer_load_dwordx2 v[104:105], v6, s[60:63], s80 offen offset:1024 sc1
    v_mfma_f32_16x16x32_bf16 v[124:127], v[184:187], v[68:71], v[124:127]
    ds_read_b64_tr_b16 v[164:165], v197 offset:12864
    ds_read_b64_tr_b16 v[166:167], v197 offset:16064
    v_mfma_f32_16x16x32_bf16 v[128:131], v[188:191], v[68:71], v[128:131]
    ds_read_b64_tr_b16 v[168:169], v197 offset:12896
    ds_read_b64_tr_b16 v[170:171], v197 offset:16096
    v_mfma_f32_16x16x32_bf16 v[132:135], v[192:195], v[68:71], v[132:135]
    ds_read_b64_tr_b16 v[172:173], v197 offset:12928
    ds_read_b64_tr_b16 v[174:175], v197 offset:16128
    s_waitcnt lgkmcnt(10)
    s_waitcnt vmcnt(9)
    v_mfma_f32_16x16x32_bf16 v[116:119], v[136:139], v[72:75], v[116:119]
    ds_read_b64_tr_b16 v[176:177], v197 offset:19200
    ds_read_b64_tr_b16 v[178:179], v197 offset:22400
    v_mfma_f32_16x16x32_bf16 v[120:123], v[140:143], v[72:75], v[120:123]
    ds_read_b64_tr_b16 v[180:181], v197 offset:19232
    ds_read_b64_tr_b16 v[182:183], v197 offset:22432
    buffer_load_dwordx2 v[106:107], v6, s[60:63], s80 offen offset:1536 sc1
    v_mfma_f32_16x16x32_bf16 v[124:127], v[144:147], v[72:75], v[124:127]
    ds_read_b64_tr_b16 v[184:185], v197 offset:19264
    ds_read_b64_tr_b16 v[186:187], v197 offset:22464
    v_mfma_f32_16x16x32_bf16 v[128:131], v[148:151], v[72:75], v[128:131]
    ds_read_b64_tr_b16 v[188:189], v197 offset:19296
    ds_read_b64_tr_b16 v[190:191], v197 offset:22496
    v_mfma_f32_16x16x32_bf16 v[132:135], v[152:155], v[72:75], v[132:135]
    ds_read_b64_tr_b16 v[192:193], v197 offset:19328
    ds_read_b64_tr_b16 v[194:195], v197 offset:22528
    s_waitcnt lgkmcnt(10)
    s_waitcnt vmcnt(9)
    v_mfma_f32_16x16x32_bf16 v[116:119], v[156:159], v[76:79], v[116:119]
    ds_read_b64_tr_b16 v[136:137], v197 offset:25600
    ds_read_b64_tr_b16 v[138:139], v197 offset:28800
    v_mfma_f32_16x16x32_bf16 v[120:123], v[160:163], v[76:79], v[120:123]
    ds_read_b64_tr_b16 v[140:141], v197 offset:25632
    ds_read_b64_tr_b16 v[142:143], v197 offset:28832
    buffer_load_dwordx2 v[108:109], v6, s[60:63], s80 offen offset:2048 sc1
    v_mfma_f32_16x16x32_bf16 v[124:127], v[164:167], v[76:79], v[124:127]
    ds_read_b64_tr_b16 v[144:145], v197 offset:25664
    ds_read_b64_tr_b16 v[146:147], v197 offset:28864
    v_mfma_f32_16x16x32_bf16 v[128:131], v[168:171], v[76:79], v[128:131]
    ds_read_b64_tr_b16 v[148:149], v197 offset:25696
    ds_read_b64_tr_b16 v[150:151], v197 offset:28896
    v_mfma_f32_16x16x32_bf16 v[132:135], v[172:175], v[76:79], v[132:135]
    ds_read_b64_tr_b16 v[152:153], v197 offset:25728
    ds_read_b64_tr_b16 v[154:155], v197 offset:28928
    s_waitcnt lgkmcnt(10)
    s_waitcnt vmcnt(9)
    v_mfma_f32_16x16x32_bf16 v[116:119], v[176:179], v[80:83], v[116:119]
    ds_read_b64_tr_b16 v[156:157], v197 offset:32000
    ds_read_b64_tr_b16 v[158:159], v197 offset:35200
    v_mfma_f32_16x16x32_bf16 v[120:123], v[180:183], v[80:83], v[120:123]
    ds_read_b64_tr_b16 v[160:161], v197 offset:32032
    ds_read_b64_tr_b16 v[162:163], v197 offset:35232
    buffer_load_dwordx2 v[110:111], v6, s[60:63], s80 offen offset:2560 sc1
    v_mfma_f32_16x16x32_bf16 v[124:127], v[184:187], v[80:83], v[124:127]
    ds_read_b64_tr_b16 v[164:165], v197 offset:32064
    ds_read_b64_tr_b16 v[166:167], v197 offset:35264
    v_mfma_f32_16x16x32_bf16 v[128:131], v[188:191], v[80:83], v[128:131]
    ds_read_b64_tr_b16 v[168:169], v197 offset:32096
    ds_read_b64_tr_b16 v[170:171], v197 offset:35296
    v_mfma_f32_16x16x32_bf16 v[132:135], v[192:195], v[80:83], v[132:135]
    ds_read_b64_tr_b16 v[172:173], v197 offset:32128
    ds_read_b64_tr_b16 v[174:175], v197 offset:35328
    s_waitcnt lgkmcnt(10)
    s_waitcnt vmcnt(9)
    v_mfma_f32_16x16x32_bf16 v[116:119], v[136:139], v[84:87], v[116:119]
    ds_read_b64_tr_b16 v[176:177], v197 offset:38400
    ds_read_b64_tr_b16 v[178:179], v197 offset:41600
    v_mfma_f32_16x16x32_bf16 v[120:123], v[140:143], v[84:87], v[120:123]
    ds_read_b64_tr_b16 v[180:181], v197 offset:38432
    ds_read_b64_tr_b16 v[182:183], v197 offset:41632
    buffer_load_dwordx2 v[112:113], v6, s[60:63], s80 offen offset:3072 sc1
    v_mfma_f32_16x16x32_bf16 v[124:127], v[144:147], v[84:87], v[124:127]
    ds_read_b64_tr_b16 v[184:185], v197 offset:38464
    ds_read_b64_tr_b16 v[186:187], v197 offset:41664
    v_mfma_f32_16x16x32_bf16 v[128:131], v[148:151], v[84:87], v[128:131]
    ds_read_b64_tr_b16 v[188:189], v197 offset:38496
    ds_read_b64_tr_b16 v[190:191], v197 offset:41696
    v_mfma_f32_16x16x32_bf16 v[132:135], v[152:155], v[84:87], v[132:135]
    ds_read_b64_tr_b16 v[192:193], v197 offset:38528
    ds_read_b64_tr_b16 v[194:195], v197 offset:41728
    s_waitcnt lgkmcnt(10)
    s_waitcnt vmcnt(9)
    v_mfma_f32_16x16x32_bf16 v[116:119], v[156:159], v[88:91], v[116:119]
    ds_read_b64_tr_b16 v[136:137], v197 offset:44800
    ds_read_b64_tr_b16 v[138:139], v197 offset:48000
    v_mfma_f32_16x16x32_bf16 v[120:123], v[160:163], v[88:91], v[120:123]
    ds_read_b64_tr_b16 v[140:141], v197 offset:44832
    ds_read_b64_tr_b16 v[142:143], v197 offset:48032
    buffer_load_dwordx2 v[114:115], v6, s[60:63], s80 offen offset:3584 sc1
    v_mfma_f32_16x16x32_bf16 v[124:127], v[164:167], v[88:91], v[124:127]
    ds_read_b64_tr_b16 v[144:145], v197 offset:44864
    ds_read_b64_tr_b16 v[146:147], v197 offset:48064
    v_mfma_f32_16x16x32_bf16 v[128:131], v[168:171], v[88:91], v[128:131]
    ds_read_b64_tr_b16 v[148:149], v197 offset:44896
    ds_read_b64_tr_b16 v[150:151], v197 offset:48096
    v_mfma_f32_16x16x32_bf16 v[132:135], v[172:175], v[88:91], v[132:135]
    ds_read_b64_tr_b16 v[152:153], v197 offset:44928
    ds_read_b64_tr_b16 v[154:155], v197 offset:48128
    s_waitcnt lgkmcnt(10)
    s_waitcnt vmcnt(9)
    v_mfma_f32_16x16x32_bf16 v[116:119], v[176:179], v[92:95], v[116:119]
    ds_read_b64_tr_b16 v[156:157], v198 offset:0
    ds_read_b64_tr_b16 v[158:159], v198 offset:12800
    v_mfma_f32_16x16x32_bf16 v[120:123], v[180:183], v[92:95], v[120:123]
    ds_read_b64_tr_b16 v[160:161], v198 offset:32
    ds_read_b64_tr_b16 v[162:163], v198 offset:12832
    v_mfma_f32_16x16x32_bf16 v[124:127], v[184:187], v[92:95], v[124:127]
    ds_read_b64_tr_b16 v[164:165], v198 offset:64
    ds_read_b64_tr_b16 v[166:167], v198 offset:12864
    v_mfma_f32_16x16x32_bf16 v[128:131], v[188:191], v[92:95], v[128:131]
    ds_read_b64_tr_b16 v[168:169], v198 offset:96
    ds_read_b64_tr_b16 v[170:171], v198 offset:12896
    v_mfma_f32_16x16x32_bf16 v[132:135], v[192:195], v[92:95], v[132:135]
    ds_read_b64_tr_b16 v[172:173], v198 offset:128
    ds_read_b64_tr_b16 v[174:175], v198 offset:12928
    s_waitcnt lgkmcnt(10)
    s_waitcnt vmcnt(8)
    v_mfma_f32_16x16x32_bf16 v[116:119], v[136:139], v[96:99], v[116:119]
    ds_read_b64_tr_b16 v[176:177], v198 offset:25600
    ds_read_b64_tr_b16 v[178:179], v198 offset:38400
    v_mfma_f32_16x16x32_bf16 v[120:123], v[140:143], v[96:99], v[120:123]
    ds_read_b64_tr_b16 v[180:181], v198 offset:25632
    ds_read_b64_tr_b16 v[182:183], v198 offset:38432
    v_mfma_f32_16x16x32_bf16 v[124:127], v[144:147], v[96:99], v[124:127]
    ds_read_b64_tr_b16 v[184:185], v198 offset:25664
    ds_read_b64_tr_b16 v[186:187], v198 offset:38464
    v_mfma_f32_16x16x32_bf16 v[128:131], v[148:151], v[96:99], v[128:131]
    ds_read_b64_tr_b16 v[188:189], v198 offset:25696
    ds_read_b64_tr_b16 v[190:191], v198 offset:38496
    v_mfma_f32_16x16x32_bf16 v[132:135], v[152:155], v[96:99], v[132:135]
    ds_read_b64_tr_b16 v[192:193], v198 offset:25728
    ds_read_b64_tr_b16 v[194:195], v198 offset:38528
    s_waitcnt lgkmcnt(10)
    s_waitcnt vmcnt(6)
    v_mfma_f32_16x16x32_bf16 v[116:119], v[156:159], v[100:103], v[116:119]
    ds_read_b64_tr_b16 v[136:137], v199 offset:0
    ds_read_b64_tr_b16 v[138:139], v199 offset:12800
    v_mfma_f32_16x16x32_bf16 v[120:123], v[160:163], v[100:103], v[120:123]
    ds_read_b64_tr_b16 v[140:141], v199 offset:32
    ds_read_b64_tr_b16 v[142:143], v199 offset:12832
    v_mfma_f32_16x16x32_bf16 v[124:127], v[164:167], v[100:103], v[124:127]
    ds_read_b64_tr_b16 v[144:145], v199 offset:64
    ds_read_b64_tr_b16 v[146:147], v199 offset:12864
    v_mfma_f32_16x16x32_bf16 v[128:131], v[168:171], v[100:103], v[128:131]
    ds_read_b64_tr_b16 v[148:149], v199 offset:96
    ds_read_b64_tr_b16 v[150:151], v199 offset:12896
    v_mfma_f32_16x16x32_bf16 v[132:135], v[172:175], v[100:103], v[132:135]
    ds_read_b64_tr_b16 v[152:153], v199 offset:128
    ds_read_b64_tr_b16 v[154:155], v199 offset:12928
    s_waitcnt lgkmcnt(10)
    s_waitcnt vmcnt(4)
    v_mfma_f32_16x16x32_bf16 v[116:119], v[176:179], v[104:107], v[116:119]
    ds_read_b64_tr_b16 v[156:157], v199 offset:25600
    ds_read_b64_tr_b16 v[158:159], v199 offset:38400
    v_mfma_f32_16x16x32_bf16 v[120:123], v[180:183], v[104:107], v[120:123]
    ds_read_b64_tr_b16 v[160:161], v199 offset:25632
    ds_read_b64_tr_b16 v[162:163], v199 offset:38432
    v_mfma_f32_16x16x32_bf16 v[124:127], v[184:187], v[104:107], v[124:127]
    ds_read_b64_tr_b16 v[164:165], v199 offset:25664
    ds_read_b64_tr_b16 v[166:167], v199 offset:38464
    v_mfma_f32_16x16x32_bf16 v[128:131], v[188:191], v[104:107], v[128:131]
    ds_read_b64_tr_b16 v[168:169], v199 offset:25696
    ds_read_b64_tr_b16 v[170:171], v199 offset:38496
    v_mfma_f32_16x16x32_bf16 v[132:135], v[192:195], v[104:107], v[132:135]
    ds_read_b64_tr_b16 v[172:173], v199 offset:25728
    ds_read_b64_tr_b16 v[174:175], v199 offset:38528
    s_waitcnt lgkmcnt(10)
    s_waitcnt vmcnt(2)
    v_mfma_f32_16x16x32_bf16 v[116:119], v[136:139], v[108:111], v[116:119]
    v_mfma_f32_16x16x32_bf16 v[120:123], v[140:143], v[108:111], v[120:123]
    v_mfma_f32_16x16x32_bf16 v[124:127], v[144:147], v[108:111], v[124:127]
    v_mfma_f32_16x16x32_bf16 v[128:131], v[148:151], v[108:111], v[128:131]
    v_mfma_f32_16x16x32_bf16 v[132:135], v[152:155], v[108:111], v[132:135]
    s_waitcnt lgkmcnt(0)
    s_waitcnt vmcnt(0)
    v_mfma_f32_16x16x32_bf16 v[116:119], v[156:159], v[112:115], v[116:119]
    v_mfma_f32_16x16x32_bf16 v[120:123], v[160:163], v[112:115], v[120:123]
    v_mfma_f32_16x16x32_bf16 v[124:127], v[164:167], v[112:115], v[124:127]
    v_mfma_f32_16x16x32_bf16 v[128:131], v[168:171], v[112:115], v[128:131]
    v_mfma_f32_16x16x32_bf16 v[132:135], v[172:175], v[112:115], v[132:135]
    s_mov_b32 s11, 0xffff0000
    s_lshl_b32 s10, s5, 2
    s_add_u32 s10, s10, s9
    s_mul_i32 s10, s10, 20480
    s_add_u32 s10, s10, 5767168
    s_lshl_b32 s12, s6, 11
    s_add_u32 s12, s12, s10
    s_lshr_b32 s13, s6, 1
    s_add_u32 s13, s13, 16
    s_lshl_b32 s13, s13, 10
    s_and_b32 s14, s6, 1
    s_lshl_b32 s14, s14, 9
    s_add_u32 s13, s13, s14
    s_add_u32 s13, s13, s10
    v_lshlrev_b32 v20, 16, v8
    v_and_b32 v21, s11, v8
    v_pk_add_f32 v[20:21], v[20:21], v[116:117]
    v_cvt_pk_bf16_f32 v8, v20, v21
    v_lshlrev_b32 v22, 16, v9
    v_and_b32 v23, s11, v9
    v_pk_add_f32 v[22:23], v[22:23], v[118:119]
    v_cvt_pk_bf16_f32 v9, v22, v23
    v_lshlrev_b32 v24, 16, v10
    v_and_b32 v25, s11, v10
    v_pk_add_f32 v[24:25], v[24:25], v[120:121]
    v_cvt_pk_bf16_f32 v10, v24, v25
    v_lshlrev_b32 v26, 16, v11
    v_and_b32 v27, s11, v11
    v_pk_add_f32 v[26:27], v[26:27], v[122:123]
    v_cvt_pk_bf16_f32 v11, v26, v27
    v_lshlrev_b32 v20, 16, v12
    v_and_b32 v21, s11, v12
    v_pk_add_f32 v[20:21], v[20:21], v[124:125]
    v_cvt_pk_bf16_f32 v12, v20, v21
    v_lshlrev_b32 v22, 16, v13
    v_and_b32 v23, s11, v13
    v_pk_add_f32 v[22:23], v[22:23], v[126:127]
    v_cvt_pk_bf16_f32 v13, v22, v23
    v_lshlrev_b32 v24, 16, v14
    v_and_b32 v25, s11, v14
    v_pk_add_f32 v[24:25], v[24:25], v[128:129]
    v_cvt_pk_bf16_f32 v14, v24, v25
    v_lshlrev_b32 v26, 16, v15
    v_and_b32 v27, s11, v15
    v_pk_add_f32 v[26:27], v[26:27], v[130:131]
    v_cvt_pk_bf16_f32 v15, v26, v27
    v_lshlrev_b32 v20, 16, v16
    v_and_b32 v21, s11, v16
    v_pk_add_f32 v[20:21], v[20:21], v[132:133]
    v_cvt_pk_bf16_f32 v16, v20, v21
    v_lshlrev_b32 v22, 16, v17
    v_and_b32 v23, s11, v17
    v_pk_add_f32 v[22:23], v[22:23], v[134:135]
    v_cvt_pk_bf16_f32 v17, v22, v23
    buffer_store_dwordx4 v[8:11], v3, s[60:63], s12 offen sc1
    buffer_store_dwordx4 v[12:15], v3, s[60:63], s12 offen offset:1024 sc1
    buffer_store_dwordx2 v[16:17], v6, s[60:63], s13 offen sc1
    v_add_u32 v168, 0, v3
    s_lshl_b32 s10, s9, 10
    v_add_u32 v169, s10, v168
    v_lshrrev_b32 v20, 2, v1
    v_lshl_add_u32 v20, v2, 2, v20
    v_bfe_u32 v21, v20, 1, 2
    v_mul_u32_u24 v20, 384, v20
    v_and_b32 v22, 3, v0
    v_lshl_add_u32 v20, v22, 3, v20
    v_add_u32 v20, 81920, v20
    s_mul_i32 s10, s9, 3
    s_add_u32 s11, s10, 0
    v_add_u32 v22, s11, v21
    v_cmp_le_u32 vcc, 12, v22
    v_subrev_u32 v23, 12, v22
    s_nop 0
    v_cndmask_b32 v22, v22, v23, vcc
    v_lshl_add_u32 v174, v22, 5, v20
    v_add_u32 v177, 24576, v174
    s_add_u32 s11, s10, 1
    v_add_u32 v22, s11, v21
    v_cmp_le_u32 vcc, 12, v22
    v_subrev_u32 v23, 12, v22
    s_nop 0
    v_cndmask_b32 v22, v22, v23, vcc
    v_lshl_add_u32 v175, v22, 5, v20
    v_add_u32 v178, 24576, v175
    s_add_u32 s11, s10, 2
    v_add_u32 v22, s11, v21
    v_cmp_le_u32 vcc, 12, v22
    v_subrev_u32 v23, 12, v22
    s_nop 0
    v_cndmask_b32 v22, v22, v23, vcc
    v_lshl_add_u32 v176, v22, 5, v20
    v_add_u32 v179, 24576, v176
    v_mov_b32 v36, 0
    v_mov_b32 v37, 0
    v_mov_b32 v38, 0
    v_mov_b32 v39, 0
    v_mov_b32 v40, 0
    v_mov_b32 v41, 0
    v_mov_b32 v42, 0
    v_mov_b32 v43, 0
    v_mov_b32 v44, 0
    v_mov_b32 v45, 0
    v_mov_b32 v46, 0
    v_mov_b32 v47, 0
    v_mov_b32 v48, 0
    v_mov_b32 v49, 0
    v_mov_b32 v50, 0
    v_mov_b32 v51, 0
    v_mov_b32 v52, 0
    v_mov_b32 v53, 0
    v_mov_b32 v54, 0
    v_mov_b32 v55, 0
    v_mov_b32 v56, 0
    v_mov_b32 v57, 0
    v_mov_b32 v58, 0
    v_mov_b32 v59, 0
    v_mov_b32 v60, 0
    v_mov_b32 v61, 0
    v_mov_b32 v62, 0
    v_mov_b32 v63, 0
    v_mov_b32 v64, 0
    v_mov_b32 v65, 0
    v_mov_b32 v66, 0
    v_mov_b32 v67, 0
    v_mov_b32 v68, 0
    v_mov_b32 v69, 0
    v_mov_b32 v70, 0
    v_mov_b32 v71, 0
    v_mov_b32 v72, 0
    v_mov_b32 v73, 0
    v_mov_b32 v74, 0
    v_mov_b32 v75, 0
    v_mov_b32 v76, 0
    v_mov_b32 v77, 0
    v_mov_b32 v78, 0
    v_mov_b32 v79, 0
    v_mov_b32 v80, 0
    v_mov_b32 v81, 0
    v_mov_b32 v82, 0
    v_mov_b32 v83, 0
    v_mov_b32 v84, 0
    v_mov_b32 v85, 0
    v_mov_b32 v86, 0
    v_mov_b32 v87, 0
    v_mov_b32 v88, 0
    v_mov_b32 v89, 0
    v_mov_b32 v90, 0
    v_mov_b32 v91, 0
    v_mov_b32 v92, 0
    v_mov_b32 v93, 0
    v_mov_b32 v94, 0
    v_mov_b32 v95, 0
    v_mov_b32 v96, 0
    v_mov_b32 v100, 0
    v_mov_b32 v97, 0
    v_mov_b32 v101, 0
    v_mov_b32 v98, 0
    v_mov_b32 v102, 0
    v_mov_b32 v99, 0
    v_mov_b32 v103, 0
    v_mov_b32 v136, 0
    v_mov_b32 v137, 0
    v_mov_b32 v138, 0
    v_mov_b32 v139, 0
    v_mov_b32 v140, 0
    v_mov_b32 v141, 0
    v_mov_b32 v142, 0
    v_mov_b32 v143, 0
    v_mov_b32 v144, 0
    v_mov_b32 v145, 0
    v_mov_b32 v146, 0
    v_mov_b32 v147, 0
    v_mov_b32 v148, 0
    v_mov_b32 v149, 0
    v_mov_b32 v150, 0
    v_mov_b32 v151, 0
    v_mov_b32 v152, 0
    v_mov_b32 v153, 0
    v_mov_b32 v154, 0
    v_mov_b32 v155, 0
    v_mov_b32 v156, 0
    v_mov_b32 v157, 0
    v_mov_b32 v158, 0
    v_mov_b32 v159, 0
    v_mov_b32 v160, 0
    v_mov_b32 v161, 0
    v_mov_b32 v162, 0
    v_mov_b32 v163, 0
    v_mov_b32 v164, 0
    v_mov_b32 v165, 0
    v_mov_b32 v166, 0
    v_mov_b32 v167, 0
    s_lshl_b32 s83, s38, 14
    s_mov_b32 s77, 24576
    s_mov_b32 s76, 8
    v_add_u32 v170, s83, v168
    v_add_u32 v172, s83, v169
    v_add_u32 v171, 4096, v170
    v_add_u32 v173, 4096, v172
    v_mov_b32 v24, 156164
    v_mov_b32 v25, 1
    s_waitcnt vmcnt(0)
    s_mov_b64 exec, 1
    ds_add_rtn_u32 v26, v24, v25
    s_mov_b64 exec, -1
    s_waitcnt lgkmcnt(0)
    v_readfirstlane_b32 s10, v26
    s_nop 3
    s_cmp_lg_u32 s10, 3
    s_cbranch_scc1 L_pub_18
    s_lshl_b32 s10, s5, 7
    s_lshl_b32 s11, s6, 2
    s_add_u32 s10, s10, s11
    s_add_u32 s10, s10, 16384
    v_mov_b32 v24, s7
    s_mov_b64 exec, 1
    buffer_store_dword v24, v4, s[60:63], s10 offen sc1
    s_mov_b64 exec, -1
L_pub_18:
    s_mov_b32 s68, s26
    s_mov_b32 s69, s27
    s_mov_b32 s70, 3072
    s_mov_b32 s71, 0x00020000
    s_mul_i32 s10, s6, 384
    s_mul_i32 s11, s9, 96
    s_add_u32 s10, s10, s11
    v_lshlrev_b32 v20, 3, v2
    buffer_load_dwordx2 v[180:181], v20, s[68:71], s10 offen offset:0
    buffer_load_dwordx2 v[182:183], v20, s[68:71], s10 offen offset:32
    buffer_load_dwordx2 v[184:185], v20, s[68:71], s10 offen offset:64
L_p4_19:
    s_barrier
    ds_read_b128 v[104:107], v170 offset:0
    v_mfma_f32_16x16x32_bf16 v[36:39], v[156:159], v[136:139], v[36:39]
    ds_read_b128 v[108:111], v170 offset:1024
    s_add_u32 s77, s77, 24576
    v_mfma_f32_16x16x32_bf16 v[48:51], v[156:159], v[140:143], v[48:51]
    ds_read_b128 v[112:115], v170 offset:2048
    s_cmp_eq_u32 s77, 73728
    v_mfma_f32_16x16x32_bf16 v[60:63], v[156:159], v[144:147], v[60:63]
    ds_read_b128 v[116:119], v170 offset:3072
    s_cselect_b32 s77, 0, s77
    v_mfma_f32_16x16x32_bf16 v[72:75], v[156:159], v[148:151], v[72:75]
    ds_read_b128 v[120:123], v172
    s_add_u32 s83, s83, 8192
    v_mfma_f32_16x16x32_bf16 v[84:87], v[156:159], v[28:31], v[84:87]
    ds_read_b64_tr_b16 v[124:125], v177 offset:0
    s_and_b32 s83, s83, 0xffff
    v_mfma_f32_16x16x32_bf16 v[40:43], v[160:163], v[136:139], v[40:43]
    ds_read_b64_tr_b16 v[126:127], v177 offset:6144
    s_add_u32 s10, s83, 4096
    v_mfma_f32_16x16x32_bf16 v[52:55], v[160:163], v[140:143], v[52:55]
    ds_read_b64_tr_b16 v[128:129], v178 offset:0
    v_mfma_f32_16x16x32_bf16 v[64:67], v[160:163], v[144:147], v[64:67]
    ds_read_b64_tr_b16 v[130:131], v178 offset:6144
    v_mfma_f32_16x16x32_bf16 v[76:79], v[160:163], v[148:151], v[76:79]
    ds_read_b64_tr_b16 v[132:133], v179 offset:0
    v_mfma_f32_16x16x32_bf16 v[88:91], v[160:163], v[28:31], v[88:91]
    ds_read_b64_tr_b16 v[134:135], v179 offset:6144
    v_mfma_f32_16x16x32_bf16 v[44:47], v[164:167], v[136:139], v[44:47]
    v_mfma_f32_16x16x32_bf16 v[56:59], v[164:167], v[140:143], v[56:59]
    v_mfma_f32_16x16x32_bf16 v[68:71], v[164:167], v[144:147], v[68:71]
    v_mfma_f32_16x16x32_bf16 v[80:83], v[164:167], v[148:151], v[80:83]
    v_mfma_f32_16x16x32_bf16 v[92:95], v[164:167], v[28:31], v[92:95]
    v_mfma_f32_16x16x32_bf16 v[96:99], v[28:31], v[152:155], v[96:99]
    v_mfma_f32_16x16x32_bf16 v[100:103], v[152:155], v[152:155], v[100:103]
    s_waitcnt lgkmcnt(0)
    ds_read_b128 v[136:139], v171 offset:0
    v_mfma_f32_16x16x32_bf16 v[36:39], v[124:127], v[104:107], v[36:39]
    ds_read_b128 v[140:143], v171 offset:1024
    v_mfma_f32_16x16x32_bf16 v[48:51], v[124:127], v[108:111], v[48:51]
    ds_read_b128 v[144:147], v171 offset:2048
    v_add_u32 v170, s83, v168
    v_mfma_f32_16x16x32_bf16 v[60:63], v[124:127], v[112:115], v[60:63]
    ds_read_b128 v[148:151], v171 offset:3072
    v_add_u32 v172, s83, v169
    v_mfma_f32_16x16x32_bf16 v[72:75], v[124:127], v[116:119], v[72:75]
    ds_read_b128 v[152:155], v173
    s_sub_u32 s76, s76, 1
    v_mfma_f32_16x16x32_bf16 v[84:87], v[124:127], v[28:31], v[84:87]
    ds_read_b64_tr_b16 v[156:157], v177 offset:12288
    s_cmp_lg_u32 s76, 0
    v_mfma_f32_16x16x32_bf16 v[40:43], v[128:131], v[104:107], v[40:43]
    ds_read_b64_tr_b16 v[158:159], v177 offset:18432
    v_mfma_f32_16x16x32_bf16 v[52:55], v[128:131], v[108:111], v[52:55]
    ds_read_b64_tr_b16 v[160:161], v178 offset:12288
    v_mfma_f32_16x16x32_bf16 v[64:67], v[128:131], v[112:115], v[64:67]
    ds_read_b64_tr_b16 v[162:163], v178 offset:18432
    v_mfma_f32_16x16x32_bf16 v[76:79], v[128:131], v[116:119], v[76:79]
    ds_read_b64_tr_b16 v[164:165], v179 offset:12288
    v_mfma_f32_16x16x32_bf16 v[88:91], v[128:131], v[28:31], v[88:91]
    ds_read_b64_tr_b16 v[166:167], v179 offset:18432
    v_mfma_f32_16x16x32_bf16 v[44:47], v[132:135], v[104:107], v[44:47]
    v_add_u32 v171, s10, v168
    v_add_u32 v173, s10, v169
    v_mfma_f32_16x16x32_bf16 v[56:59], v[132:135], v[108:111], v[56:59]
    v_add_u32 v177, s77, v174
    v_add_u32 v178, s77, v175
    v_mfma_f32_16x16x32_bf16 v[68:71], v[132:135], v[112:115], v[68:71]
    v_add_u32 v179, s77, v176
    v_mfma_f32_16x16x32_bf16 v[80:83], v[132:135], v[116:119], v[80:83]
    v_mfma_f32_16x16x32_bf16 v[92:95], v[132:135], v[28:31], v[92:95]
    v_mfma_f32_16x16x32_bf16 v[96:99], v[28:31], v[120:123], v[96:99]
    v_mfma_f32_16x16x32_bf16 v[100:103], v[120:123], v[120:123], v[100:103]
    s_waitcnt lgkmcnt(0)
    s_cbranch_scc1 L_p4_19
    v_add_u32 v168, 65536, v6
    s_lshl_b32 s10, s9, 10
    v_add_u32 v169, s10, v168
    s_and_b32 s83, s38, 1
    s_lshl_b32 s83, s83, 13
    s_add_u32 s10, s83, 4096
    s_mov_b32 s76, 2
    v_add_u32 v170, s83, v168
    v_add_u32 v172, s83, v169
    v_add_u32 v171, s10, v168
    v_add_u32 v173, s10, v169
L_p4s_20:
    s_barrier
    ds_read_b64 v[104:105], v170 offset:0
    v_mfma_f32_16x16x32_bf16 v[36:39], v[156:159], v[136:139], v[36:39]
    ds_read_b64 v[106:107], v170 offset:512
    s_add_u32 s77, s77, 24576
    v_mfma_f32_16x16x32_bf16 v[48:51], v[156:159], v[140:143], v[48:51]
    ds_read_b64 v[108:109], v170 offset:1024
    s_cmp_eq_u32 s77, 73728
    v_mfma_f32_16x16x32_bf16 v[60:63], v[156:159], v[144:147], v[60:63]
    ds_read_b64 v[110:111], v170 offset:1536
    s_cselect_b32 s77, 0, s77
    v_mfma_f32_16x16x32_bf16 v[72:75], v[156:159], v[148:151], v[72:75]
    ds_read_b64 v[112:113], v170 offset:2048
    s_xor_b32 s83, s83, 8192
    v_mfma_f32_16x16x32_bf16 v[84:87], v[156:159], v[28:31], v[84:87]
    ds_read_b64 v[114:115], v170 offset:2560
    s_add_u32 s10, s83, 4096
    v_mfma_f32_16x16x32_bf16 v[40:43], v[160:163], v[136:139], v[40:43]
    ds_read_b64 v[116:117], v170 offset:3072
    v_mfma_f32_16x16x32_bf16 v[52:55], v[160:163], v[140:143], v[52:55]
    ds_read_b64 v[118:119], v170 offset:3584
    v_mfma_f32_16x16x32_bf16 v[64:67], v[160:163], v[144:147], v[64:67]
    ds_read_b64 v[120:121], v172
    v_mfma_f32_16x16x32_bf16 v[76:79], v[160:163], v[148:151], v[76:79]
    ds_read_b64 v[122:123], v172 offset:512
    v_mfma_f32_16x16x32_bf16 v[88:91], v[160:163], v[28:31], v[88:91]
    ds_read_b64_tr_b16 v[124:125], v177 offset:0
    v_mfma_f32_16x16x32_bf16 v[44:47], v[164:167], v[136:139], v[44:47]
    ds_read_b64_tr_b16 v[126:127], v177 offset:6144
    v_mfma_f32_16x16x32_bf16 v[56:59], v[164:167], v[140:143], v[56:59]
    ds_read_b64_tr_b16 v[128:129], v178 offset:0
    v_mfma_f32_16x16x32_bf16 v[68:71], v[164:167], v[144:147], v[68:71]
    ds_read_b64_tr_b16 v[130:131], v178 offset:6144
    v_mfma_f32_16x16x32_bf16 v[80:83], v[164:167], v[148:151], v[80:83]
    ds_read_b64_tr_b16 v[132:133], v179 offset:0
    v_mfma_f32_16x16x32_bf16 v[92:95], v[164:167], v[28:31], v[92:95]
    ds_read_b64_tr_b16 v[134:135], v179 offset:6144
    v_mfma_f32_16x16x32_bf16 v[96:99], v[28:31], v[152:155], v[96:99]
    v_mfma_f32_16x16x32_bf16 v[100:103], v[152:155], v[152:155], v[100:103]
    s_waitcnt lgkmcnt(0)
    ds_read_b64 v[136:137], v171 offset:0
    v_mfma_f32_16x16x32_bf16 v[36:39], v[124:127], v[104:107], v[36:39]
    ds_read_b64 v[138:139], v171 offset:512
    v_mfma_f32_16x16x32_bf16 v[48:51], v[124:127], v[108:111], v[48:51]
    ds_read_b64 v[140:141], v171 offset:1024
    v_add_u32 v170, s83, v168
    v_mfma_f32_16x16x32_bf16 v[60:63], v[124:127], v[112:115], v[60:63]
    ds_read_b64 v[142:143], v171 offset:1536
    v_add_u32 v172, s83, v169
    v_mfma_f32_16x16x32_bf16 v[72:75], v[124:127], v[116:119], v[72:75]
    ds_read_b64 v[144:145], v171 offset:2048
    s_sub_u32 s76, s76, 1
    v_mfma_f32_16x16x32_bf16 v[84:87], v[124:127], v[28:31], v[84:87]
    ds_read_b64 v[146:147], v171 offset:2560
    s_cmp_lg_u32 s76, 0
    v_mfma_f32_16x16x32_bf16 v[40:43], v[128:131], v[104:107], v[40:43]
    ds_read_b64 v[148:149], v171 offset:3072
    v_mfma_f32_16x16x32_bf16 v[52:55], v[128:131], v[108:111], v[52:55]
    ds_read_b64 v[150:151], v171 offset:3584
    v_mfma_f32_16x16x32_bf16 v[64:67], v[128:131], v[112:115], v[64:67]
    ds_read_b64 v[152:153], v173
    v_mfma_f32_16x16x32_bf16 v[76:79], v[128:131], v[116:119], v[76:79]
    ds_read_b64 v[154:155], v173 offset:512
    v_mfma_f32_16x16x32_bf16 v[88:91], v[128:131], v[28:31], v[88:91]
    ds_read_b64_tr_b16 v[156:157], v177 offset:12288
    v_mfma_f32_16x16x32_bf16 v[44:47], v[132:135], v[104:107], v[44:47]
    ds_read_b64_tr_b16 v[158:159], v177 offset:18432
    v_mfma_f32_16x16x32_bf16 v[56:59], v[132:135], v[108:111], v[56:59]
    ds_read_b64_tr_b16 v[160:161], v178 offset:12288
    v_mfma_f32_16x16x32_bf16 v[68:71], v[132:135], v[112:115], v[68:71]
    ds_read_b64_tr_b16 v[162:163], v178 offset:18432
    v_mfma_f32_16x16x32_bf16 v[80:83], v[132:135], v[116:119], v[80:83]
    ds_read_b64_tr_b16 v[164:165], v179 offset:12288
    v_mfma_f32_16x16x32_bf16 v[92:95], v[132:135], v[28:31], v[92:95]
    ds_read_b64_tr_b16 v[166:167], v179 offset:18432
    v_mfma_f32_16x16x32_bf16 v[96:99], v[28:31], v[120:123], v[96:99]
    v_add_u32 v171, s10, v168
    v_add_u32 v173, s10, v169
    v_mfma_f32_16x16x32_bf16 v[100:103], v[120:123], v[120:123], v[100:103]
    v_add_u32 v177, s77, v174
    v_add_u32 v178, s77, v175
    v_add_u32 v179, s77, v176
    s_waitcnt lgkmcnt(0)
    s_cbranch_scc1 L_p4s_20
    v_mfma_f32_16x16x32_bf16 v[36:39], v[156:159], v[136:139], v[36:39]
    v_mfma_f32_16x16x32_bf16 v[48:51], v[156:159], v[140:143], v[48:51]
    v_mfma_f32_16x16x32_bf16 v[60:63], v[156:159], v[144:147], v[60:63]
    v_mfma_f32_16x16x32_bf16 v[72:75], v[156:159], v[148:151], v[72:75]
    v_mfma_f32_16x16x32_bf16 v[84:87], v[156:159], v[28:31], v[84:87]
    v_mfma_f32_16x16x32_bf16 v[40:43], v[160:163], v[136:139], v[40:43]
    v_mfma_f32_16x16x32_bf16 v[52:55], v[160:163], v[140:143], v[52:55]
    v_mfma_f32_16x16x32_bf16 v[64:67], v[160:163], v[144:147], v[64:67]
    v_mfma_f32_16x16x32_bf16 v[76:79], v[160:163], v[148:151], v[76:79]
    v_mfma_f32_16x16x32_bf16 v[88:91], v[160:163], v[28:31], v[88:91]
    v_mfma_f32_16x16x32_bf16 v[44:47], v[164:167], v[136:139], v[44:47]
    v_mfma_f32_16x16x32_bf16 v[56:59], v[164:167], v[140:143], v[56:59]
    v_mfma_f32_16x16x32_bf16 v[68:71], v[164:167], v[144:147], v[68:71]
    v_mfma_f32_16x16x32_bf16 v[80:83], v[164:167], v[148:151], v[80:83]
    v_mfma_f32_16x16x32_bf16 v[92:95], v[164:167], v[28:31], v[92:95]
    v_mfma_f32_16x16x32_bf16 v[96:99], v[28:31], v[152:155], v[96:99]
    v_mfma_f32_16x16x32_bf16 v[100:103], v[152:155], v[152:155], v[100:103]
    s_lshl_b32 s10, s9, 6
    s_add_u32 s10, s10, 155648
    v_lshl_add_u32 v22, v1, 2, s10
    s_nop 5
    v_cndmask_b32 v20, v100, v101, s[84:85]
    v_mul_f32 v21, 0x3acccccd, v96
    v_cndmask_b32 v20, v20, v102, s[86:87]
    v_cndmask_b32 v20, v20, v103, s[88:89]
    v_mul_f32 v20, 0x3acccccd, v20
    v_fma_f32 v20, -v21, v21, v20
    v_max_f32 v20, 0, v20
    v_add_f32 v20, 0x3727c5ac, v20
    v_rsq_f32 v20, v20
    s_mov_b32 exec_lo, 0x00F0000F
    s_mov_b32 exec_hi, 0xF0000F00
    v_mul_f32 v21, v21, v20
    ds_write_b32 v22, v20
    ds_write_b32 v22, v21 offset:256
    s_mov_b64 exec, -1
    s_waitcnt lgkmcnt(0)
    s_barrier
    v_lshlrev_b32 v20, 2, v1
    v_add_u32 v20, 155648, v20
    ds_read_b32 v188, v20 offset:0
    ds_read_b32 v192, v20 offset:256
    ds_read_b32 v189, v20 offset:64
    ds_read_b32 v193, v20 offset:320
    ds_read_b32 v190, v20 offset:128
    ds_read_b32 v194, v20 offset:384
    ds_read_b32 v191, v20 offset:192
    ds_read_b32 v195, v20 offset:448
    v_mov_b32 v208, 0xc0135761
    v_mov_b32 v209, 0xc0135761
    v_mov_b32 v210, 0xbdd2d3e8
    v_mov_b32 v211, 0xbdd2d3e8
    v_mov_b32 v212, 1.0
    v_mov_b32 v213, 1.0
    s_mov_b32 s11, 0xffff0000
    s_lshl_b32 s10, s5, 2
    s_mul_i32 s10, s10, 49152
    s_add_u32 s10, s10, 8388608
    s_mul_i32 s13, s6, 6
    s_add_u32 s14, s13, s9
    s_lshl_b32 s14, s14, 10
    s_add_u32 s14, s14, s10
    s_lshr_b32 s15, s9, 1
    s_add_u32 s15, s15, s13
    s_add_u32 s15, s15, 4
    s_lshl_b32 s15, s15, 10
    s_add_u32 s15, s15, s10
    s_lshl_b32 s12, s9, 10
    s_add_u32 s12, s12, 158720
    v_add_u32 v214, s12, v6
    s_xor_b32 s12, s9, 1
    s_lshl_b32 s12, s12, 10
    s_add_u32 s12, s12, 158720
    v_add_u32 v215, s12, v6
    s_lshl_b32 s12, s9, 2
    s_add_u32 s12, s12, 156208
    v_mov_b32 v216, s12
    v_mov_b32 v217, 1
    s_xor_b32 s12, s12, 4
    v_mov_b32 v218, s12
    s_waitcnt vmcnt(0) lgkmcnt(0)
    v_lshlrev_b32 v196, 16, v180
    v_and_b32 v197, s11, v180
    v_lshlrev_b32 v198, 16, v181
    v_and_b32 v199, s11, v181
    v_lshlrev_b32 v200, 16, v182
    v_and_b32 v201, s11, v182
    v_lshlrev_b32 v202, 16, v183
    v_and_b32 v203, s11, v183
    v_lshlrev_b32 v204, 16, v184
    v_and_b32 v205, s11, v184
    v_lshlrev_b32 v206, 16, v185
    v_and_b32 v207, s11, v185
    v_pk_fma_f32 v[136:137], v[192:193], v[84:85], v[196:197] op_sel:[0,0,0] op_sel_hi:[0,1,1] neg_lo:[1,0,0] neg_hi:[1,0,0]
    v_pk_fma_f32 v[138:139], v[192:193], v[86:87], v[198:199] op_sel:[0,0,0] op_sel_hi:[0,1,1] neg_lo:[1,0,0] neg_hi:[1,0,0]
    v_pk_fma_f32 v[140:141], v[192:193], v[88:89], v[200:201] op_sel:[0,0,0] op_sel_hi:[0,1,1] neg_lo:[1,0,0] neg_hi:[1,0,0]
    v_pk_fma_f32 v[142:143], v[192:193], v[90:91], v[202:203] op_sel:[0,0,0] op_sel_hi:[0,1,1] neg_lo:[1,0,0] neg_hi:[1,0,0]
    v_pk_fma_f32 v[144:145], v[192:193], v[92:93], v[204:205] op_sel:[0,0,0] op_sel_hi:[0,1,1] neg_lo:[1,0,0] neg_hi:[1,0,0]
    v_pk_fma_f32 v[146:147], v[192:193], v[94:95], v[206:207] op_sel:[0,0,0] op_sel_hi:[0,1,1] neg_lo:[1,0,0] neg_hi:[1,0,0]
    v_pk_fma_f32 v[36:37], v[36:37], v[188:189], v[136:137] op_sel:[0,0,0] op_sel_hi:[1,0,1]
    v_pk_fma_f32 v[38:39], v[38:39], v[188:189], v[138:139] op_sel:[0,0,0] op_sel_hi:[1,0,1]
    v_pk_fma_f32 v[40:41], v[40:41], v[188:189], v[140:141] op_sel:[0,0,0] op_sel_hi:[1,0,1]
    v_pk_fma_f32 v[42:43], v[42:43], v[188:189], v[142:143] op_sel:[0,0,0] op_sel_hi:[1,0,1]
    v_pk_fma_f32 v[44:45], v[44:45], v[188:189], v[144:145] op_sel:[0,0,0] op_sel_hi:[1,0,1]
    v_pk_fma_f32 v[46:47], v[46:47], v[188:189], v[146:147] op_sel:[0,0,0] op_sel_hi:[1,0,1]
    v_pk_mul_f32 v[104:105], v[36:37], v[36:37]
    v_pk_mul_f32 v[106:107], v[38:39], v[38:39]
    v_pk_mul_f32 v[108:109], v[40:41], v[40:41]
    v_pk_mul_f32 v[110:111], v[42:43], v[42:43]
    v_pk_mul_f32 v[112:113], v[44:45], v[44:45]
    v_pk_mul_f32 v[114:115], v[46:47], v[46:47]
    v_pk_fma_f32 v[104:105], v[104:105], v[210:211], v[208:209]
    v_pk_fma_f32 v[106:107], v[106:107], v[210:211], v[208:209]
    v_pk_fma_f32 v[108:109], v[108:109], v[210:211], v[208:209]
    v_pk_fma_f32 v[110:111], v[110:111], v[210:211], v[208:209]
    v_pk_fma_f32 v[112:113], v[112:113], v[210:211], v[208:209]
    v_pk_fma_f32 v[114:115], v[114:115], v[210:211], v[208:209]
    v_pk_mul_f32 v[104:105], v[104:105], v[36:37]
    v_pk_mul_f32 v[106:107], v[106:107], v[38:39]
    v_pk_mul_f32 v[108:109], v[108:109], v[40:41]
    v_pk_mul_f32 v[110:111], v[110:111], v[42:43]
    v_pk_mul_f32 v[112:113], v[112:113], v[44:45]
    v_pk_mul_f32 v[114:115], v[114:115], v[46:47]
    v_exp_f32 v104, v104
    v_exp_f32 v105, v105
    v_exp_f32 v106, v106
    v_exp_f32 v107, v107
    v_exp_f32 v108, v108
    v_exp_f32 v109, v109
    v_exp_f32 v110, v110
    v_exp_f32 v111, v111
    v_exp_f32 v112, v112
    v_exp_f32 v113, v113
    v_exp_f32 v114, v114
    v_exp_f32 v115, v115
    v_pk_add_f32 v[104:105], v[104:105], v[212:213]
    v_pk_add_f32 v[106:107], v[106:107], v[212:213]
    v_pk_add_f32 v[108:109], v[108:109], v[212:213]
    v_pk_add_f32 v[110:111], v[110:111], v[212:213]
    v_pk_add_f32 v[112:113], v[112:113], v[212:213]
    v_pk_add_f32 v[114:115], v[114:115], v[212:213]
    v_rcp_f32 v104, v104
    v_rcp_f32 v105, v105
    v_rcp_f32 v106, v106
    v_rcp_f32 v107, v107
    v_rcp_f32 v108, v108
    v_rcp_f32 v109, v109
    v_rcp_f32 v110, v110
    v_rcp_f32 v111, v111
    v_rcp_f32 v112, v112
    v_rcp_f32 v113, v113
    v_rcp_f32 v114, v114
    v_rcp_f32 v115, v115
    v_pk_mul_f32 v[36:37], v[36:37], v[104:105]
    v_pk_mul_f32 v[38:39], v[38:39], v[106:107]
    v_pk_mul_f32 v[40:41], v[40:41], v[108:109]
    v_pk_mul_f32 v[42:43], v[42:43], v[110:111]
    v_pk_mul_f32 v[44:45], v[44:45], v[112:113]
    v_pk_mul_f32 v[46:47], v[46:47], v[114:115]
    v_cvt_pk_bf16_f32 v36, v36, v37
    v_cvt_pk_bf16_f32 v37, v38, v39
    v_cvt_pk_bf16_f32 v38, v40, v41
    v_cvt_pk_bf16_f32 v39, v42, v43
    v_cvt_pk_bf16_f32 v44, v44, v45
    v_cvt_pk_bf16_f32 v45, v46, v47
    buffer_store_dwordx4 v[36:39], v3, s[60:63], s14 offen sc1
    s_add_u32 s14, s14, 49152
    s_and_b32 s12, s9, 1
    s_cmp_eq_u32 s12, 0
    s_cbranch_scc1 L_hx_21
    ds_write_b64 v214, v[44:45] offset:0
L_hx_21:
    v_pk_fma_f32 v[136:137], v[192:193], v[84:85], v[196:197] op_sel:[1,0,0] op_sel_hi:[1,1,1] neg_lo:[1,0,0] neg_hi:[1,0,0]
    v_pk_fma_f32 v[138:139], v[192:193], v[86:87], v[198:199] op_sel:[1,0,0] op_sel_hi:[1,1,1] neg_lo:[1,0,0] neg_hi:[1,0,0]
    v_pk_fma_f32 v[140:141], v[192:193], v[88:89], v[200:201] op_sel:[1,0,0] op_sel_hi:[1,1,1] neg_lo:[1,0,0] neg_hi:[1,0,0]
    v_pk_fma_f32 v[142:143], v[192:193], v[90:91], v[202:203] op_sel:[1,0,0] op_sel_hi:[1,1,1] neg_lo:[1,0,0] neg_hi:[1,0,0]
    v_pk_fma_f32 v[144:145], v[192:193], v[92:93], v[204:205] op_sel:[1,0,0] op_sel_hi:[1,1,1] neg_lo:[1,0,0] neg_hi:[1,0,0]
    v_pk_fma_f32 v[146:147], v[192:193], v[94:95], v[206:207] op_sel:[1,0,0] op_sel_hi:[1,1,1] neg_lo:[1,0,0] neg_hi:[1,0,0]
    v_pk_fma_f32 v[48:49], v[48:49], v[188:189], v[136:137] op_sel:[0,1,0] op_sel_hi:[1,1,1]
    v_pk_fma_f32 v[50:51], v[50:51], v[188:189], v[138:139] op_sel:[0,1,0] op_sel_hi:[1,1,1]
    v_pk_fma_f32 v[52:53], v[52:53], v[188:189], v[140:141] op_sel:[0,1,0] op_sel_hi:[1,1,1]
    v_pk_fma_f32 v[54:55], v[54:55], v[188:189], v[142:143] op_sel:[0,1,0] op_sel_hi:[1,1,1]
    v_pk_fma_f32 v[56:57], v[56:57], v[188:189], v[144:145] op_sel:[0,1,0] op_sel_hi:[1,1,1]
    v_pk_fma_f32 v[58:59], v[58:59], v[188:189], v[146:147] op_sel:[0,1,0] op_sel_hi:[1,1,1]
    v_pk_mul_f32 v[104:105], v[48:49], v[48:49]
    v_pk_mul_f32 v[106:107], v[50:51], v[50:51]
    v_pk_mul_f32 v[108:109], v[52:53], v[52:53]
    v_pk_mul_f32 v[110:111], v[54:55], v[54:55]
    v_pk_mul_f32 v[112:113], v[56:57], v[56:57]
    v_pk_mul_f32 v[114:115], v[58:59], v[58:59]
    v_pk_fma_f32 v[104:105], v[104:105], v[210:211], v[208:209]
    v_pk_fma_f32 v[106:107], v[106:107], v[210:211], v[208:209]
    v_pk_fma_f32 v[108:109], v[108:109], v[210:211], v[208:209]
    v_pk_fma_f32 v[110:111], v[110:111], v[210:211], v[208:209]
    v_pk_fma_f32 v[112:113], v[112:113], v[210:211], v[208:209]
    v_pk_fma_f32 v[114:115], v[114:115], v[210:211], v[208:209]
    v_pk_mul_f32 v[104:105], v[104:105], v[48:49]
    v_pk_mul_f32 v[106:107], v[106:107], v[50:51]
    v_pk_mul_f32 v[108:109], v[108:109], v[52:53]
    v_pk_mul_f32 v[110:111], v[110:111], v[54:55]
    v_pk_mul_f32 v[112:113], v[112:113], v[56:57]
    v_pk_mul_f32 v[114:115], v[114:115], v[58:59]
    v_exp_f32 v104, v104
    v_exp_f32 v105, v105
    v_exp_f32 v106, v106
    v_exp_f32 v107, v107
    v_exp_f32 v108, v108
    v_exp_f32 v109, v109
    v_exp_f32 v110, v110
    v_exp_f32 v111, v111
    v_exp_f32 v112, v112
    v_exp_f32 v113, v113
    v_exp_f32 v114, v114
    v_exp_f32 v115, v115
    v_pk_add_f32 v[104:105], v[104:105], v[212:213]
    v_pk_add_f32 v[106:107], v[106:107], v[212:213]
    v_pk_add_f32 v[108:109], v[108:109], v[212:213]
    v_pk_add_f32 v[110:111], v[110:111], v[212:213]
    v_pk_add_f32 v[112:113], v[112:113], v[212:213]
    v_pk_add_f32 v[114:115], v[114:115], v[212:213]
    v_rcp_f32 v104, v104
    v_rcp_f32 v105, v105
    v_rcp_f32 v106, v106
    v_rcp_f32 v107, v107
    v_rcp_f32 v108, v108
    v_rcp_f32 v109, v109
    v_rcp_f32 v110, v110
    v_rcp_f32 v111, v111
    v_rcp_f32 v112, v112
    v_rcp_f32 v113, v113
    v_rcp_f32 v114, v114
    v_rcp_f32 v115, v115
    v_pk_mul_f32 v[48:49], v[48:49], v[104:105]
    v_pk_mul_f32 v[50:51], v[50:51], v[106:107]
    v_pk_mul_f32 v[52:53], v[52:53], v[108:109]
    v_pk_mul_f32 v[54:55], v[54:55], v[110:111]
    v_pk_mul_f32 v[56:57], v[56:57], v[112:113]
    v_pk_mul_f32 v[58:59], v[58:59], v[114:115]
    v_cvt_pk_bf16_f32 v48, v48, v49
    v_cvt_pk_bf16_f32 v49, v50, v51
    v_cvt_pk_bf16_f32 v50, v52, v53
    v_cvt_pk_bf16_f32 v51, v54, v55
    v_cvt_pk_bf16_f32 v56, v56, v57
    v_cvt_pk_bf16_f32 v57, v58, v59
    buffer_store_dwordx4 v[48:51], v3, s[60:63], s14 offen sc1
    s_add_u32 s14, s14, 49152
    s_and_b32 s12, s9, 1
    s_cmp_eq_u32 s12, 0
    s_cbranch_scc1 L_hx_22
    ds_write_b64 v214, v[56:57] offset:512
    s_waitcnt lgkmcnt(0)
    s_mov_b64 exec, 1
    ds_write_b32 v216, v217
    s_mov_b64 exec, -1
L_hx_22:
    v_pk_fma_f32 v[136:137], v[194:195], v[84:85], v[196:197] op_sel:[0,0,0] op_sel_hi:[0,1,1] neg_lo:[1,0,0] neg_hi:[1,0,0]
    v_pk_fma_f32 v[138:139], v[194:195], v[86:87], v[198:199] op_sel:[0,0,0] op_sel_hi:[0,1,1] neg_lo:[1,0,0] neg_hi:[1,0,0]
    v_pk_fma_f32 v[140:141], v[194:195], v[88:89], v[200:201] op_sel:[0,0,0] op_sel_hi:[0,1,1] neg_lo:[1,0,0] neg_hi:[1,0,0]
    v_pk_fma_f32 v[142:143], v[194:195], v[90:91], v[202:203] op_sel:[0,0,0] op_sel_hi:[0,1,1] neg_lo:[1,0,0] neg_hi:[1,0,0]
    v_pk_fma_f32 v[144:145], v[194:195], v[92:93], v[204:205] op_sel:[0,0,0] op_sel_hi:[0,1,1] neg_lo:[1,0,0] neg_hi:[1,0,0]
    v_pk_fma_f32 v[146:147], v[194:195], v[94:95], v[206:207] op_sel:[0,0,0] op_sel_hi:[0,1,1] neg_lo:[1,0,0] neg_hi:[1,0,0]
    v_pk_fma_f32 v[60:61], v[60:61], v[190:191], v[136:137] op_sel:[0,0,0] op_sel_hi:[1,0,1]
    v_pk_fma_f32 v[62:63], v[62:63], v[190:191], v[138:139] op_sel:[0,0,0] op_sel_hi:[1,0,1]
    v_pk_fma_f32 v[64:65], v[64:65], v[190:191], v[140:141] op_sel:[0,0,0] op_sel_hi:[1,0,1]
    v_pk_fma_f32 v[66:67], v[66:67], v[190:191], v[142:143] op_sel:[0,0,0] op_sel_hi:[1,0,1]
    v_pk_fma_f32 v[68:69], v[68:69], v[190:191], v[144:145] op_sel:[0,0,0] op_sel_hi:[1,0,1]
    v_pk_fma_f32 v[70:71], v[70:71], v[190:191], v[146:147] op_sel:[0,0,0] op_sel_hi:[1,0,1]
    v_pk_mul_f32 v[104:105], v[60:61], v[60:61]
    v_pk_mul_f32 v[106:107], v[62:63], v[62:63]
    v_pk_mul_f32 v[108:109], v[64:65], v[64:65]
    v_pk_mul_f32 v[110:111], v[66:67], v[66:67]
    v_pk_mul_f32 v[112:113], v[68:69], v[68:69]
    v_pk_mul_f32 v[114:115], v[70:71], v[70:71]
    v_pk_fma_f32 v[104:105], v[104:105], v[210:211], v[208:209]
    v_pk_fma_f32 v[106:107], v[106:107], v[210:211], v[208:209]
    v_pk_fma_f32 v[108:109], v[108:109], v[210:211], v[208:209]
    v_pk_fma_f32 v[110:111], v[110:111], v[210:211], v[208:209]
    v_pk_fma_f32 v[112:113], v[112:113], v[210:211], v[208:209]
    v_pk_fma_f32 v[114:115], v[114:115], v[210:211], v[208:209]
    v_pk_mul_f32 v[104:105], v[104:105], v[60:61]
    v_pk_mul_f32 v[106:107], v[106:107], v[62:63]
    v_pk_mul_f32 v[108:109], v[108:109], v[64:65]
    v_pk_mul_f32 v[110:111], v[110:111], v[66:67]
    v_pk_mul_f32 v[112:113], v[112:113], v[68:69]
    v_pk_mul_f32 v[114:115], v[114:115], v[70:71]
    v_exp_f32 v104, v104
    v_exp_f32 v105, v105
    v_exp_f32 v106, v106
    v_exp_f32 v107, v107
    v_exp_f32 v108, v108
    v_exp_f32 v109, v109
    v_exp_f32 v110, v110
    v_exp_f32 v111, v111
    v_exp_f32 v112, v112
    v_exp_f32 v113, v113
    v_exp_f32 v114, v114
    v_exp_f32 v115, v115
    v_pk_add_f32 v[104:105], v[104:105], v[212:213]
    v_pk_add_f32 v[106:107], v[106:107], v[212:213]
    v_pk_add_f32 v[108:109], v[108:109], v[212:213]
    v_pk_add_f32 v[110:111], v[110:111], v[212:213]
    v_pk_add_f32 v[112:113], v[112:113], v[212:213]
    v_pk_add_f32 v[114:115], v[114:115], v[212:213]
    v_rcp_f32 v104, v104
    v_rcp_f32 v105, v105
    v_rcp_f32 v106, v106
    v_rcp_f32 v107, v107
    v_rcp_f32 v108, v108
    v_rcp_f32 v109, v109
    v_rcp_f32 v110, v110
    v_rcp_f32 v111, v111
    v_rcp_f32 v112, v112
    v_rcp_f32 v113, v113
    v_rcp_f32 v114, v114
    v_rcp_f32 v115, v115
    v_pk_mul_f32 v[60:61], v[60:61], v[104:105]
    v_pk_mul_f32 v[62:63], v[62:63], v[106:107]
    v_pk_mul_f32 v[64:65], v[64:65], v[108:109]
    v_pk_mul_f32 v[66:67], v[66:67], v[110:111]
    v_pk_mul_f32 v[68:69], v[68:69], v[112:113]
    v_pk_mul_f32 v[70:71], v[70:71], v[114:115]
    v_cvt_pk_bf16_f32 v60, v60, v61
    v_cvt_pk_bf16_f32 v61, v62, v63
    v_cvt_pk_bf16_f32 v62, v64, v65
    v_cvt_pk_bf16_f32 v63, v66, v67
    v_cvt_pk_bf16_f32 v68, v68, v69
    v_cvt_pk_bf16_f32 v69, v70, v71
    buffer_store_dwordx4 v[60:63], v3, s[60:63], s14 offen sc1
    s_add_u32 s14, s14, 49152
    s_and_b32 s12, s9, 1
    s_cmp_eq_u32 s12, 1
    s_cbranch_scc1 L_hx_23
    ds_write_b64 v214, v[68:69] offset:0
L_hx_23:
    v_pk_fma_f32 v[136:137], v[194:195], v[84:85], v[196:197] op_sel:[1,0,0] op_sel_hi:[1,1,1] neg_lo:[1,0,0] neg_hi:[1,0,0]
    v_pk_fma_f32 v[138:139], v[194:195], v[86:87], v[198:199] op_sel:[1,0,0] op_sel_hi:[1,1,1] neg_lo:[1,0,0] neg_hi:[1,0,0]
    v_pk_fma_f32 v[140:141], v[194:195], v[88:89], v[200:201] op_sel:[1,0,0] op_sel_hi:[1,1,1] neg_lo:[1,0,0] neg_hi:[1,0,0]
    v_pk_fma_f32 v[142:143], v[194:195], v[90:91], v[202:203] op_sel:[1,0,0] op_sel_hi:[1,1,1] neg_lo:[1,0,0] neg_hi:[1,0,0]
    v_pk_fma_f32 v[144:145], v[194:195], v[92:93], v[204:205] op_sel:[1,0,0] op_sel_hi:[1,1,1] neg_lo:[1,0,0] neg_hi:[1,0,0]
    v_pk_fma_f32 v[146:147], v[194:195], v[94:95], v[206:207] op_sel:[1,0,0] op_sel_hi:[1,1,1] neg_lo:[1,0,0] neg_hi:[1,0,0]
    v_pk_fma_f32 v[72:73], v[72:73], v[190:191], v[136:137] op_sel:[0,1,0] op_sel_hi:[1,1,1]
    v_pk_fma_f32 v[74:75], v[74:75], v[190:191], v[138:139] op_sel:[0,1,0] op_sel_hi:[1,1,1]
    v_pk_fma_f32 v[76:77], v[76:77], v[190:191], v[140:141] op_sel:[0,1,0] op_sel_hi:[1,1,1]
    v_pk_fma_f32 v[78:79], v[78:79], v[190:191], v[142:143] op_sel:[0,1,0] op_sel_hi:[1,1,1]
    v_pk_fma_f32 v[80:81], v[80:81], v[190:191], v[144:145] op_sel:[0,1,0] op_sel_hi:[1,1,1]
    v_pk_fma_f32 v[82:83], v[82:83], v[190:191], v[146:147] op_sel:[0,1,0] op_sel_hi:[1,1,1]
    v_pk_mul_f32 v[104:105], v[72:73], v[72:73]
    v_pk_mul_f32 v[106:107], v[74:75], v[74:75]
    v_pk_mul_f32 v[108:109], v[76:77], v[76:77]
    v_pk_mul_f32 v[110:111], v[78:79], v[78:79]
    v_pk_mul_f32 v[112:113], v[80:81], v[80:81]
    v_pk_mul_f32 v[114:115], v[82:83], v[82:83]
    v_pk_fma_f32 v[104:105], v[104:105], v[210:211], v[208:209]
    v_pk_fma_f32 v[106:107], v[106:107], v[210:211], v[208:209]
    v_pk_fma_f32 v[108:109], v[108:109], v[210:211], v[208:209]
    v_pk_fma_f32 v[110:111], v[110:111], v[210:211], v[208:209]
    v_pk_fma_f32 v[112:113], v[112:113], v[210:211], v[208:209]
    v_pk_fma_f32 v[114:115], v[114:115], v[210:211], v[208:209]
    v_pk_mul_f32 v[104:105], v[104:105], v[72:73]
    v_pk_mul_f32 v[106:107], v[106:107], v[74:75]
    v_pk_mul_f32 v[108:109], v[108:109], v[76:77]
    v_pk_mul_f32 v[110:111], v[110:111], v[78:79]
    v_pk_mul_f32 v[112:113], v[112:113], v[80:81]
    v_pk_mul_f32 v[114:115], v[114:115], v[82:83]
    v_exp_f32 v104, v104
    v_exp_f32 v105, v105
    v_exp_f32 v106, v106
    v_exp_f32 v107, v107
    v_exp_f32 v108, v108
    v_exp_f32 v109, v109
    v_exp_f32 v110, v110
    v_exp_f32 v111, v111
    v_exp_f32 v112, v112
    v_exp_f32 v113, v113
    v_exp_f32 v114, v114
    v_exp_f32 v115, v115
    v_pk_add_f32 v[104:105], v[104:105], v[212:213]
    v_pk_add_f32 v[106:107], v[106:107], v[212:213]
    v_pk_add_f32 v[108:109], v[108:109], v[212:213]
    v_pk_add_f32 v[110:111], v[110:111], v[212:213]
    v_pk_add_f32 v[112:113], v[112:113], v[212:213]
    v_pk_add_f32 v[114:115], v[114:115], v[212:213]
    v_rcp_f32 v104, v104
    v_rcp_f32 v105, v105
    v_rcp_f32 v106, v106
    v_rcp_f32 v107, v107
    v_rcp_f32 v108, v108
    v_rcp_f32 v109, v109
    v_rcp_f32 v110, v110
    v_rcp_f32 v111, v111
    v_rcp_f32 v112, v112
    v_rcp_f32 v113, v113
    v_rcp_f32 v114, v114
    v_rcp_f32 v115, v115
    v_pk_mul_f32 v[72:73], v[72:73], v[104:105]
    v_pk_mul_f32 v[74:75], v[74:75], v[106:107]
    v_pk_mul_f32 v[76:77], v[76:77], v[108:109]
    v_pk_mul_f32 v[78:79], v[78:79], v[110:111]
    v_pk_mul_f32 v[80:81], v[80:81], v[112:113]
    v_pk_mul_f32 v[82:83], v[82:83], v[114:115]
    v_cvt_pk_bf16_f32 v72, v72, v73
    v_cvt_pk_bf16_f32 v73, v74, v75
    v_cvt_pk_bf16_f32 v74, v76, v77
    v_cvt_pk_bf16_f32 v75, v78, v79
    v_cvt_pk_bf16_f32 v80, v80, v81
    v_cvt_pk_bf16_f32 v81, v82, v83
    buffer_store_dwordx4 v[72:75], v3, s[60:63], s14 offen sc1
    s_and_b32 s12, s9, 1
    s_cmp_eq_u32 s12, 1
    s_cbranch_scc1 L_hx_24
    ds_write_b64 v214, v[80:81] offset:512
    s_waitcnt lgkmcnt(0)
    s_mov_b64 exec, 1
    ds_write_b32 v216, v217
    s_mov_b64 exec, -1
L_hx_24:
    s_mov_b32 s78, 0
L_hw_25:
    ds_read_b32 v20, v218
    s_waitcnt lgkmcnt(0)
    v_readfirstlane_b32 s10, v20
    s_add_u32 s78, s78, 1
    s_cmp_gt_u32 s78, 1600000
    s_cbranch_scc1 L_hwe_26
    s_cmp_eq_u32 s10, 0
    s_cbranch_scc1 L_hw_25
L_hwe_26:
    s_and_b32 s12, s9, 1
    s_cmp_eq_u32 s12, 1
    s_cbranch_scc1 L_ho_27
    ds_read_b64 v[106:107], v215
    ds_read_b64 v[110:111], v215 offset:512
    v_mov_b32 v104, v44
    v_mov_b32 v105, v45
    v_mov_b32 v108, v56
    v_mov_b32 v109, v57
    s_branch L_hf_28
L_ho_27:
    ds_read_b64 v[104:105], v215
    ds_read_b64 v[108:109], v215 offset:512
    v_mov_b32 v106, v68
    v_mov_b32 v107, v69
    v_mov_b32 v110, v80
    v_mov_b32 v111, v81
    s_add_u32 s15, s15, 98304
L_hf_28:
    s_add_u32 s13, s15, 49152
    s_waitcnt lgkmcnt(0)
    buffer_store_dwordx4 v[104:107], v3, s[60:63], s15 offen sc1
    buffer_store_dwordx4 v[108:111], v3, s[60:63], s13 offen sc1
    s_lshl_b32 s81, s5, 2
    s_add_u32 s81, s81, s9
    s_mul_i32 s81, s81, 49152
    s_add_u32 s81, s81, 8388608
    s_mul_i32 s80, s38, 12288
    v_mov_b32 v20, 156168
    v_mov_b32 v21, 1
    s_waitcnt vmcnt(0)
    s_mov_b64 exec, 1
    ds_add_rtn_u32 v22, v20, v21
    s_mov_b64 exec, -1
    s_waitcnt lgkmcnt(0)
    v_readfirstlane_b32 s10, v22
    s_nop 3
    s_cmp_lg_u32 s10, 3
    s_cbranch_scc1 L_pub_29
    s_lshl_b32 s10, s5, 7
    s_lshl_b32 s11, s6, 2
    s_add_u32 s10, s10, s11
    s_add_u32 s10, s10, 20480
    v_mov_b32 v20, s7
    s_mov_b64 exec, 1
    buffer_store_dword v20, v4, s[60:63], s10 offen sc1
    s_mov_b64 exec, -1
L_pub_29:
    v_mov_b32 v108, 0
    v_mov_b32 v109, 0
    v_mov_b32 v110, 0
    v_mov_b32 v111, 0
    v_mov_b32 v112, 0
    v_mov_b32 v113, 0
    v_mov_b32 v114, 0
    v_mov_b32 v115, 0
    v_mov_b32 v116, 0
    v_mov_b32 v117, 0
    v_mov_b32 v118, 0
    v_mov_b32 v119, 0
    v_mov_b32 v120, 0
    v_mov_b32 v121, 0
    v_mov_b32 v122, 0
    v_mov_b32 v123, 0
    v_mov_b32 v124, 0
    v_mov_b32 v125, 0
    v_mov_b32 v126, 0
    v_mov_b32 v127, 0
    s_mov_b32 s72, s30
    s_mov_b32 s73, s31
    s_mov_b32 s74, 1280
    s_mov_b32 s75, 0x00020000
    s_mul_i32 s10, s6, 160
    v_lshlrev_b32 v20, 3, v2
    buffer_load_dwordx2 v[190:191], v20, s[72:75], s10 offen offset:0
    buffer_load_dwordx2 v[192:193], v20, s[72:75], s10 offen offset:32
    buffer_load_dwordx2 v[194:195], v20, s[72:75], s10 offen offset:64
    buffer_load_dwordx2 v[196:197], v20, s[72:75], s10 offen offset:96
    buffer_load_dwordx2 v[198:199], v20, s[72:75], s10 offen offset:128
    v_mov_b32 v20, 156184
    s_cmp_lg_u32 s9, 0
    s_cbranch_scc1 L_shf_30
    s_lshl_b32 s10, s5, 7
    s_add_u32 s10, s10, 20480
    s_add_u32 s100, s36, s10
    s_addc_u32 s101, s37, 0
    s_mov_b32 s78, 0
L_sq_34:
    s_load_dwordx8 s[64:71], s[100:101], 0 glc
    s_waitcnt lgkmcnt(0)
    s_xor_b32 s10, s64, s7
    s_xor_b32 s11, s65, s7
    s_or_b32 s10, s10, s11
    s_xor_b32 s11, s66, s7
    s_or_b32 s10, s10, s11
    s_xor_b32 s11, s67, s7
    s_or_b32 s10, s10, s11
    s_xor_b32 s11, s68, s7
    s_or_b32 s10, s10, s11
    s_xor_b32 s11, s69, s7
    s_or_b32 s10, s10, s11
    s_xor_b32 s11, s70, s7
    s_or_b32 s10, s10, s11
    s_xor_b32 s11, s71, s7
    s_or_b32 s10, s10, s11
    s_cmp_eq_u32 s10, 0
    s_cbranch_scc1 L_sqd_35
    s_add_u32 s78, s78, 1
    s_cmp_lt_u32 s78, 200000
    s_cbranch_scc1 L_sq_34
L_sqd_35:
    v_mov_b32 v21, 1
    s_mov_b64 exec, 1
    ds_write_b32 v20, v21
    s_mov_b64 exec, -1
    s_waitcnt lgkmcnt(0)
    s_branch L_she_31
L_shf_30:
    s_mov_b32 s78, 0
L_shl_32:
    ds_read_b32 v21, v20
    s_waitcnt lgkmcnt(0)
    v_readfirstlane_b32 s10, v21
    s_add_u32 s78, s78, 1
    s_cmp_gt_u32 s78, 1600000
    s_cbranch_scc1 L_she_31
    s_cmp_eq_u32 s10, 0
    s_cbranch_scc1 L_shl_32
L_she_31:
    s_mov_b32 s64, s32
    s_mov_b32 s65, s33
    s_mov_b32 s66, 2621440
    s_mov_b32 s67, 0x00020000
    s_add_u32 s79, s81, s80
    s_add_u32 s15, s79, 4096
    buffer_load_dwordx4 v[36:39], v3, s[60:63], s79 offen offset:0 sc1
    buffer_load_dwordx4 v[40:43], v3, s[60:63], s79 offen offset:1024 sc1
    buffer_load_dwordx4 v[52:55], v3, s[60:63], s15 offen offset:0 sc1
    buffer_load_dwordx4 v[44:47], v3, s[60:63], s79 offen offset:2048 sc1
    buffer_load_dwordx4 v[48:51], v3, s[60:63], s79 offen offset:3072 sc1
    buffer_load_dwordx4 v[56:59], v3, s[60:63], s15 offen offset:1024 sc1
    s_add_u32 s80, s80, 6144
    s_cmp_eq_u32 s80, 49152
    s_cselect_b32 s80, 0, s80
    s_barrier
    v_add_u32 v188, 0, v3
    ds_read_b128 v[128:131], v188 offset:0
    ds_read_b128 v[132:135], v188 offset:1024
    ds_read_b128 v[136:139], v188 offset:2048
    ds_read_b128 v[140:143], v188 offset:3072
    ds_read_b128 v[144:147], v188 offset:4096
    ds_read_b128 v[148:151], v188 offset:5120
    ds_read_b128 v[152:155], v188 offset:6144
    ds_read_b128 v[156:159], v188 offset:7168
    ds_read_b128 v[160:163], v188 offset:8192
    ds_read_b128 v[164:167], v188 offset:9216
    s_waitcnt lgkmcnt(5)
    s_waitcnt vmcnt(5)
    v_mfma_f32_16x16x32_bf16 v[108:111], v[128:131], v[36:39], v[108:111]
    ds_read_b128 v[168:171], v188 offset:10240
    v_mfma_f32_16x16x32_bf16 v[112:115], v[132:135], v[36:39], v[112:115]
    ds_read_b128 v[172:175], v188 offset:11264
    s_add_u32 s79, s81, s80
    s_add_u32 s15, s79, 4096
    buffer_load_dwordx4 v[60:63], v3, s[60:63], s79 offen offset:0 sc1
    v_mfma_f32_16x16x32_bf16 v[116:119], v[136:139], v[36:39], v[116:119]
    ds_read_b128 v[176:179], v188 offset:12288
    v_mfma_f32_16x16x32_bf16 v[120:123], v[140:143], v[36:39], v[120:123]
    ds_read_b128 v[180:183], v188 offset:13312
    buffer_load_dwordx4 v[64:67], v3, s[60:63], s79 offen offset:1024 sc1
    v_mfma_f32_16x16x32_bf16 v[124:127], v[144:147], v[36:39], v[124:127]
    ds_read_b128 v[184:187], v188 offset:14336
    s_waitcnt lgkmcnt(5)
    s_waitcnt vmcnt(6)
    v_mfma_f32_16x16x32_bf16 v[108:111], v[148:151], v[40:43], v[108:111]
    ds_read_b128 v[128:131], v188 offset:15360
    v_mfma_f32_16x16x32_bf16 v[112:115], v[152:155], v[40:43], v[112:115]
    ds_read_b128 v[132:135], v188 offset:16384
    buffer_load_dwordx4 v[76:79], v3, s[60:63], s15 offen offset:0 sc1
    v_mfma_f32_16x16x32_bf16 v[116:119], v[156:159], v[40:43], v[116:119]
    ds_read_b128 v[136:139], v188 offset:17408
    v_mfma_f32_16x16x32_bf16 v[120:123], v[160:163], v[40:43], v[120:123]
    ds_read_b128 v[140:143], v188 offset:18432
    buffer_load_dwordx4 v[68:71], v3, s[60:63], s79 offen offset:2048 sc1
    v_mfma_f32_16x16x32_bf16 v[124:127], v[164:167], v[40:43], v[124:127]
    ds_read_b128 v[144:147], v188 offset:19456
    s_waitcnt lgkmcnt(5)
    s_waitcnt vmcnt(7)
    v_mfma_f32_16x16x32_bf16 v[108:111], v[168:171], v[52:55], v[108:111]
    ds_read_b128 v[148:151], v188 offset:20480
    v_mfma_f32_16x16x32_bf16 v[112:115], v[172:175], v[52:55], v[112:115]
    ds_read_b128 v[152:155], v188 offset:21504
    buffer_load_dwordx4 v[72:75], v3, s[60:63], s79 offen offset:3072 sc1
    v_mfma_f32_16x16x32_bf16 v[116:119], v[176:179], v[52:55], v[116:119]
    ds_read_b128 v[156:159], v188 offset:22528
    v_mfma_f32_16x16x32_bf16 v[120:123], v[180:183], v[52:55], v[120:123]
    ds_read_b128 v[160:163], v188 offset:23552
    buffer_load_dwordx4 v[80:83], v3, s[60:63], s15 offen offset:1024 sc1
    s_add_u32 s80, s80, 6144
    s_cmp_eq_u32 s80, 49152
    s_cselect_b32 s80, 0, s80
    v_mfma_f32_16x16x32_bf16 v[124:127], v[184:187], v[52:55], v[124:127]
    ds_read_b128 v[164:167], v188 offset:24576
    s_waitcnt lgkmcnt(5)
    s_waitcnt vmcnt(8)
    v_mfma_f32_16x16x32_bf16 v[108:111], v[128:131], v[44:47], v[108:111]
    ds_read_b128 v[168:171], v188 offset:25600
    v_mfma_f32_16x16x32_bf16 v[112:115], v[132:135], v[44:47], v[112:115]
    ds_read_b128 v[172:175], v188 offset:26624
    s_add_u32 s79, s81, s80
    s_add_u32 s15, s79, 4096
    buffer_load_dwordx4 v[84:87], v3, s[60:63], s79 offen offset:0 sc1
    v_mfma_f32_16x16x32_bf16 v[116:119], v[136:139], v[44:47], v[116:119]
    ds_read_b128 v[176:179], v188 offset:27648
    v_mfma_f32_16x16x32_bf16 v[120:123], v[140:143], v[44:47], v[120:123]
    ds_read_b128 v[180:183], v188 offset:28672
    buffer_load_dwordx4 v[88:91], v3, s[60:63], s79 offen offset:1024 sc1
    v_mfma_f32_16x16x32_bf16 v[124:127], v[144:147], v[44:47], v[124:127]
    ds_read_b128 v[184:187], v188 offset:29696
    s_waitcnt lgkmcnt(5)
    s_waitcnt vmcnt(9)
    s_barrier
    v_add_u32 v189, 30720, v3
    v_mfma_f32_16x16x32_bf16 v[108:111], v[148:151], v[48:51], v[108:111]
    ds_read_b128 v[128:131], v189 offset:0
    v_mfma_f32_16x16x32_bf16 v[112:115], v[152:155], v[48:51], v[112:115]
    ds_read_b128 v[132:135], v189 offset:1024
    buffer_load_dwordx4 v[100:103], v3, s[60:63], s15 offen offset:0 sc1
    v_mfma_f32_16x16x32_bf16 v[116:119], v[156:159], v[48:51], v[116:119]
    ds_read_b128 v[136:139], v189 offset:2048
    v_mfma_f32_16x16x32_bf16 v[120:123], v[160:163], v[48:51], v[120:123]
    ds_read_b128 v[140:143], v189 offset:3072
    buffer_load_dwordx4 v[92:95], v3, s[60:63], s79 offen offset:2048 sc1
    v_mfma_f32_16x16x32_bf16 v[124:127], v[164:167], v[48:51], v[124:127]
    ds_read_b128 v[144:147], v189 offset:4096
    s_waitcnt lgkmcnt(5)
    s_waitcnt vmcnt(10)
    v_mfma_f32_16x16x32_bf16 v[108:111], v[168:171], v[56:59], v[108:111]
    ds_read_b128 v[148:151], v189 offset:5120
    v_mfma_f32_16x16x32_bf16 v[112:115], v[172:175], v[56:59], v[112:115]
    ds_read_b128 v[152:155], v189 offset:6144
    buffer_load_dwordx4 v[96:99], v3, s[60:63], s79 offen offset:3072 sc1
    v_mfma_f32_16x16x32_bf16 v[116:119], v[176:179], v[56:59], v[116:119]
    ds_read_b128 v[156:159], v189 offset:7168
    v_mfma_f32_16x16x32_bf16 v[120:123], v[180:183], v[56:59], v[120:123]
    ds_read_b128 v[160:163], v189 offset:8192
    buffer_load_dwordx4 v[104:107], v3, s[60:63], s15 offen offset:1024 sc1
    s_add_u32 s80, s80, 6144
    s_cmp_eq_u32 s80, 49152
    s_cselect_b32 s80, 0, s80
    v_mfma_f32_16x16x32_bf16 v[124:127], v[184:187], v[56:59], v[124:127]
    ds_read_b128 v[164:167], v189 offset:9216
    s_waitcnt lgkmcnt(5)
    s_waitcnt vmcnt(11)
    v_mfma_f32_16x16x32_bf16 v[108:111], v[128:131], v[60:63], v[108:111]
    ds_read_b128 v[168:171], v189 offset:10240
    v_mfma_f32_16x16x32_bf16 v[112:115], v[132:135], v[60:63], v[112:115]
    ds_read_b128 v[172:175], v189 offset:11264
    s_add_u32 s79, s81, s80
    s_add_u32 s15, s79, 4096
    buffer_load_dwordx4 v[36:39], v3, s[60:63], s79 offen offset:0 sc1
    v_mfma_f32_16x16x32_bf16 v[116:119], v[136:139], v[60:63], v[116:119]
    ds_read_b128 v[176:179], v189 offset:12288
    v_mfma_f32_16x16x32_bf16 v[120:123], v[140:143], v[60:63], v[120:123]
    ds_read_b128 v[180:183], v189 offset:13312
    v_mfma_f32_16x16x32_bf16 v[124:127], v[144:147], v[60:63], v[124:127]
    ds_read_b128 v[184:187], v189 offset:14336
    s_waitcnt lgkmcnt(5)
    s_waitcnt vmcnt(11)
    v_mfma_f32_16x16x32_bf16 v[108:111], v[148:151], v[64:67], v[108:111]
    ds_read_b128 v[128:131], v189 offset:15360
    v_mfma_f32_16x16x32_bf16 v[112:115], v[152:155], v[64:67], v[112:115]
    ds_read_b128 v[132:135], v189 offset:16384
    buffer_load_dwordx4 v[40:43], v3, s[60:63], s79 offen offset:1024 sc1
    v_mfma_f32_16x16x32_bf16 v[116:119], v[156:159], v[64:67], v[116:119]
    ds_read_b128 v[136:139], v189 offset:17408
    v_mfma_f32_16x16x32_bf16 v[120:123], v[160:163], v[64:67], v[120:123]
    ds_read_b128 v[140:143], v189 offset:18432
    v_mfma_f32_16x16x32_bf16 v[124:127], v[164:167], v[64:67], v[124:127]
    ds_read_b128 v[144:147], v189 offset:19456
    s_waitcnt lgkmcnt(5)
    s_waitcnt vmcnt(11)
    v_mfma_f32_16x16x32_bf16 v[108:111], v[168:171], v[76:79], v[108:111]
    ds_read_b128 v[148:151], v189 offset:20480
    v_mfma_f32_16x16x32_bf16 v[112:115], v[172:175], v[76:79], v[112:115]
    ds_read_b128 v[152:155], v189 offset:21504
    buffer_load_dwordx4 v[52:55], v3, s[60:63], s15 offen offset:0 sc1
    v_mfma_f32_16x16x32_bf16 v[116:119], v[176:179], v[76:79], v[116:119]
    ds_read_b128 v[156:159], v189 offset:22528
    v_mfma_f32_16x16x32_bf16 v[120:123], v[180:183], v[76:79], v[120:123]
    ds_read_b128 v[160:163], v189 offset:23552
    v_mfma_f32_16x16x32_bf16 v[124:127], v[184:187], v[76:79], v[124:127]
    ds_read_b128 v[164:167], v189 offset:24576
    s_waitcnt lgkmcnt(5)
    s_waitcnt vmcnt(11)
    v_mfma_f32_16x16x32_bf16 v[108:111], v[128:131], v[68:71], v[108:111]
    ds_read_b128 v[168:171], v189 offset:25600
    v_mfma_f32_16x16x32_bf16 v[112:115], v[132:135], v[68:71], v[112:115]
    ds_read_b128 v[172:175], v189 offset:26624
    buffer_load_dwordx4 v[44:47], v3, s[60:63], s79 offen offset:2048 sc1
    v_mfma_f32_16x16x32_bf16 v[116:119], v[136:139], v[68:71], v[116:119]
    ds_read_b128 v[176:179], v189 offset:27648
    v_mfma_f32_16x16x32_bf16 v[120:123], v[140:143], v[68:71], v[120:123]
    ds_read_b128 v[180:183], v189 offset:28672
    v_mfma_f32_16x16x32_bf16 v[124:127], v[144:147], v[68:71], v[124:127]
    ds_read_b128 v[184:187], v189 offset:29696
    s_waitcnt lgkmcnt(5)
    s_waitcnt vmcnt(11)
    s_barrier
    v_add_u32 v188, 61440, v3
    v_mfma_f32_16x16x32_bf16 v[108:111], v[148:151], v[72:75], v[108:111]
    ds_read_b128 v[128:131], v188 offset:0
    v_mfma_f32_16x16x32_bf16 v[112:115], v[152:155], v[72:75], v[112:115]
    ds_read_b128 v[132:135], v188 offset:1024
    buffer_load_dwordx4 v[48:51], v3, s[60:63], s79 offen offset:3072 sc1
    v_mfma_f32_16x16x32_bf16 v[116:119], v[156:159], v[72:75], v[116:119]
    ds_read_b128 v[136:139], v188 offset:2048
    v_mfma_f32_16x16x32_bf16 v[120:123], v[160:163], v[72:75], v[120:123]
    ds_read_b128 v[140:143], v188 offset:3072
    v_mfma_f32_16x16x32_bf16 v[124:127], v[164:167], v[72:75], v[124:127]
    ds_read_b128 v[144:147], v188 offset:4096
    s_waitcnt lgkmcnt(5)
    s_waitcnt vmcnt(11)
    v_mfma_f32_16x16x32_bf16 v[108:111], v[168:171], v[80:83], v[108:111]
    ds_read_b128 v[148:151], v188 offset:5120
    v_mfma_f32_16x16x32_bf16 v[112:115], v[172:175], v[80:83], v[112:115]
    ds_read_b128 v[152:155], v188 offset:6144
    buffer_load_dwordx4 v[56:59], v3, s[60:63], s15 offen offset:1024 sc1
    s_add_u32 s80, s80, 6144
    s_cmp_eq_u32 s80, 49152
    s_cselect_b32 s80, 0, s80
    v_mfma_f32_16x16x32_bf16 v[116:119], v[176:179], v[80:83], v[116:119]
    ds_read_b128 v[156:159], v188 offset:7168
    v_mfma_f32_16x16x32_bf16 v[120:123], v[180:183], v[80:83], v[120:123]
    ds_read_b128 v[160:163], v188 offset:8192
    v_mfma_f32_16x16x32_bf16 v[124:127], v[184:187], v[80:83], v[124:127]
    ds_read_b128 v[164:167], v188 offset:9216
    s_waitcnt lgkmcnt(5)
    s_waitcnt vmcnt(11)
    v_mfma_f32_16x16x32_bf16 v[108:111], v[128:131], v[84:87], v[108:111]
    ds_read_b128 v[168:171], v188 offset:10240
    v_mfma_f32_16x16x32_bf16 v[112:115], v[132:135], v[84:87], v[112:115]
    ds_read_b128 v[172:175], v188 offset:11264
    s_add_u32 s79, s81, s80
    s_add_u32 s15, s79, 4096
    buffer_load_dwordx4 v[60:63], v3, s[60:63], s79 offen offset:0 sc1
    v_mfma_f32_16x16x32_bf16 v[116:119], v[136:139], v[84:87], v[116:119]
    ds_read_b128 v[176:179], v188 offset:12288
    v_mfma_f32_16x16x32_bf16 v[120:123], v[140:143], v[84:87], v[120:123]
    ds_read_b128 v[180:183], v188 offset:13312
    v_mfma_f32_16x16x32_bf16 v[124:127], v[144:147], v[84:87], v[124:127]
    ds_read_b128 v[184:187], v188 offset:14336
    s_waitcnt lgkmcnt(5)
    s_waitcnt vmcnt(11)
    v_mfma_f32_16x16x32_bf16 v[108:111], v[148:151], v[88:91], v[108:111]
    ds_read_b128 v[128:131], v188 offset:15360
    v_mfma_f32_16x16x32_bf16 v[112:115], v[152:155], v[88:91], v[112:115]
    ds_read_b128 v[132:135], v188 offset:16384
    buffer_load_dwordx4 v[64:67], v3, s[60:63], s79 offen offset:1024 sc1
    v_mfma_f32_16x16x32_bf16 v[116:119], v[156:159], v[88:91], v[116:119]
    ds_read_b128 v[136:139], v188 offset:17408
    v_mfma_f32_16x16x32_bf16 v[120:123], v[160:163], v[88:91], v[120:123]
    ds_read_b128 v[140:143], v188 offset:18432
    v_mfma_f32_16x16x32_bf16 v[124:127], v[164:167], v[88:91], v[124:127]
    ds_read_b128 v[144:147], v188 offset:19456
    s_waitcnt lgkmcnt(5)
    s_waitcnt vmcnt(11)
    v_mfma_f32_16x16x32_bf16 v[108:111], v[168:171], v[100:103], v[108:111]
    ds_read_b128 v[148:151], v188 offset:20480
    v_mfma_f32_16x16x32_bf16 v[112:115], v[172:175], v[100:103], v[112:115]
    ds_read_b128 v[152:155], v188 offset:21504
    buffer_load_dwordx4 v[76:79], v3, s[60:63], s15 offen offset:0 sc1
    v_mfma_f32_16x16x32_bf16 v[116:119], v[176:179], v[100:103], v[116:119]
    ds_read_b128 v[156:159], v188 offset:22528
    v_mfma_f32_16x16x32_bf16 v[120:123], v[180:183], v[100:103], v[120:123]
    ds_read_b128 v[160:163], v188 offset:23552
    v_mfma_f32_16x16x32_bf16 v[124:127], v[184:187], v[100:103], v[124:127]
    ds_read_b128 v[164:167], v188 offset:24576
    s_waitcnt lgkmcnt(5)
    s_waitcnt vmcnt(11)
    v_mfma_f32_16x16x32_bf16 v[108:111], v[128:131], v[92:95], v[108:111]
    ds_read_b128 v[168:171], v188 offset:25600
    v_mfma_f32_16x16x32_bf16 v[112:115], v[132:135], v[92:95], v[112:115]
    ds_read_b128 v[172:175], v188 offset:26624
    buffer_load_dwordx4 v[68:71], v3, s[60:63], s79 offen offset:2048 sc1
    v_mfma_f32_16x16x32_bf16 v[116:119], v[136:139], v[92:95], v[116:119]
    ds_read_b128 v[176:179], v188 offset:27648
    v_mfma_f32_16x16x32_bf16 v[120:123], v[140:143], v[92:95], v[120:123]
    ds_read_b128 v[180:183], v188 offset:28672
    v_mfma_f32_16x16x32_bf16 v[124:127], v[144:147], v[92:95], v[124:127]
    ds_read_b128 v[184:187], v188 offset:29696
    s_waitcnt lgkmcnt(5)
    s_waitcnt vmcnt(11)
    s_barrier
    v_add_u32 v189, 92160, v3
    v_mfma_f32_16x16x32_bf16 v[108:111], v[148:151], v[96:99], v[108:111]
    ds_read_b128 v[128:131], v189 offset:0
    v_mfma_f32_16x16x32_bf16 v[112:115], v[152:155], v[96:99], v[112:115]
    ds_read_b128 v[132:135], v189 offset:1024
    buffer_load_dwordx4 v[72:75], v3, s[60:63], s79 offen offset:3072 sc1
    v_mfma_f32_16x16x32_bf16 v[116:119], v[156:159], v[96:99], v[116:119]
    ds_read_b128 v[136:139], v189 offset:2048
    v_mfma_f32_16x16x32_bf16 v[120:123], v[160:163], v[96:99], v[120:123]
    ds_read_b128 v[140:143], v189 offset:3072
    v_mfma_f32_16x16x32_bf16 v[124:127], v[164:167], v[96:99], v[124:127]
    ds_read_b128 v[144:147], v189 offset:4096
    s_waitcnt lgkmcnt(5)
    s_waitcnt vmcnt(11)
    v_mfma_f32_16x16x32_bf16 v[108:111], v[168:171], v[104:107], v[108:111]
    ds_read_b128 v[148:151], v189 offset:5120
    v_mfma_f32_16x16x32_bf16 v[112:115], v[172:175], v[104:107], v[112:115]
    ds_read_b128 v[152:155], v189 offset:6144
    buffer_load_dwordx4 v[80:83], v3, s[60:63], s15 offen offset:1024 sc1
    s_add_u32 s80, s80, 6144
    s_cmp_eq_u32 s80, 49152
    s_cselect_b32 s80, 0, s80
    v_mfma_f32_16x16x32_bf16 v[116:119], v[176:179], v[104:107], v[116:119]
    ds_read_b128 v[156:159], v189 offset:7168
    v_mfma_f32_16x16x32_bf16 v[120:123], v[180:183], v[104:107], v[120:123]
    ds_read_b128 v[160:163], v189 offset:8192
    v_mfma_f32_16x16x32_bf16 v[124:127], v[184:187], v[104:107], v[124:127]
    ds_read_b128 v[164:167], v189 offset:9216
    s_waitcnt lgkmcnt(5)
    s_waitcnt vmcnt(11)
    v_mfma_f32_16x16x32_bf16 v[108:111], v[128:131], v[36:39], v[108:111]
    ds_read_b128 v[168:171], v189 offset:10240
    v_mfma_f32_16x16x32_bf16 v[112:115], v[132:135], v[36:39], v[112:115]
    ds_read_b128 v[172:175], v189 offset:11264
    s_add_u32 s79, s81, s80
    s_add_u32 s15, s79, 4096
    buffer_load_dwordx4 v[84:87], v3, s[60:63], s79 offen offset:0 sc1
    v_mfma_f32_16x16x32_bf16 v[116:119], v[136:139], v[36:39], v[116:119]
    ds_read_b128 v[176:179], v189 offset:12288
    v_mfma_f32_16x16x32_bf16 v[120:123], v[140:143], v[36:39], v[120:123]
    ds_read_b128 v[180:183], v189 offset:13312
    v_mfma_f32_16x16x32_bf16 v[124:127], v[144:147], v[36:39], v[124:127]
    ds_read_b128 v[184:187], v189 offset:14336
    s_waitcnt lgkmcnt(5)
    s_waitcnt vmcnt(11)
    v_mfma_f32_16x16x32_bf16 v[108:111], v[148:151], v[40:43], v[108:111]
    ds_read_b128 v[128:131], v189 offset:15360
    v_mfma_f32_16x16x32_bf16 v[112:115], v[152:155], v[40:43], v[112:115]
    ds_read_b128 v[132:135], v189 offset:16384
    buffer_load_dwordx4 v[88:91], v3, s[60:63], s79 offen offset:1024 sc1
    v_mfma_f32_16x16x32_bf16 v[116:119], v[156:159], v[40:43], v[116:119]
    ds_read_b128 v[136:139], v189 offset:17408
    v_mfma_f32_16x16x32_bf16 v[120:123], v[160:163], v[40:43], v[120:123]
    ds_read_b128 v[140:143], v189 offset:18432
    v_mfma_f32_16x16x32_bf16 v[124:127], v[164:167], v[40:43], v[124:127]
    ds_read_b128 v[144:147], v189 offset:19456
    s_waitcnt lgkmcnt(5)
    s_waitcnt vmcnt(11)
    v_mfma_f32_16x16x32_bf16 v[108:111], v[168:171], v[52:55], v[108:111]
    ds_read_b128 v[148:151], v189 offset:20480
    v_mfma_f32_16x16x32_bf16 v[112:115], v[172:175], v[52:55], v[112:115]
    ds_read_b128 v[152:155], v189 offset:21504
    buffer_load_dwordx4 v[100:103], v3, s[60:63], s15 offen offset:0 sc1
    v_mfma_f32_16x16x32_bf16 v[116:119], v[176:179], v[52:55], v[116:119]
    ds_read_b128 v[156:159], v189 offset:22528
    v_mfma_f32_16x16x32_bf16 v[120:123], v[180:183], v[52:55], v[120:123]
    ds_read_b128 v[160:163], v189 offset:23552
    v_mfma_f32_16x16x32_bf16 v[124:127], v[184:187], v[52:55], v[124:127]
    ds_read_b128 v[164:167], v189 offset:24576
    s_waitcnt lgkmcnt(5)
    s_waitcnt vmcnt(11)
    v_mfma_f32_16x16x32_bf16 v[108:111], v[128:131], v[44:47], v[108:111]
    ds_read_b128 v[168:171], v189 offset:25600
    v_mfma_f32_16x16x32_bf16 v[112:115], v[132:135], v[44:47], v[112:115]
    ds_read_b128 v[172:175], v189 offset:26624
    buffer_load_dwordx4 v[92:95], v3, s[60:63], s79 offen offset:2048 sc1
    v_mfma_f32_16x16x32_bf16 v[116:119], v[136:139], v[44:47], v[116:119]
    ds_read_b128 v[176:179], v189 offset:27648
    v_mfma_f32_16x16x32_bf16 v[120:123], v[140:143], v[44:47], v[120:123]
    ds_read_b128 v[180:183], v189 offset:28672
    v_mfma_f32_16x16x32_bf16 v[124:127], v[144:147], v[44:47], v[124:127]
    ds_read_b128 v[184:187], v189 offset:29696
    s_waitcnt lgkmcnt(5)
    s_waitcnt vmcnt(11)
    s_barrier
    v_add_u32 v188, 122880, v3
    v_mfma_f32_16x16x32_bf16 v[108:111], v[148:151], v[48:51], v[108:111]
    ds_read_b128 v[128:131], v188 offset:0
    v_mfma_f32_16x16x32_bf16 v[112:115], v[152:155], v[48:51], v[112:115]
    ds_read_b128 v[132:135], v188 offset:1024
    buffer_load_dwordx4 v[96:99], v3, s[60:63], s79 offen offset:3072 sc1
    v_mfma_f32_16x16x32_bf16 v[116:119], v[156:159], v[48:51], v[116:119]
    ds_read_b128 v[136:139], v188 offset:2048
    v_mfma_f32_16x16x32_bf16 v[120:123], v[160:163], v[48:51], v[120:123]
    ds_read_b128 v[140:143], v188 offset:3072
    v_mfma_f32_16x16x32_bf16 v[124:127], v[164:167], v[48:51], v[124:127]
    ds_read_b128 v[144:147], v188 offset:4096
    s_waitcnt lgkmcnt(5)
    s_waitcnt vmcnt(11)
    v_mfma_f32_16x16x32_bf16 v[108:111], v[168:171], v[56:59], v[108:111]
    ds_read_b128 v[148:151], v188 offset:5120
    v_mfma_f32_16x16x32_bf16 v[112:115], v[172:175], v[56:59], v[112:115]
    ds_read_b128 v[152:155], v188 offset:6144
    buffer_load_dwordx4 v[104:107], v3, s[60:63], s15 offen offset:1024 sc1
    s_add_u32 s80, s80, 6144
    s_cmp_eq_u32 s80, 49152
    s_cselect_b32 s80, 0, s80
    v_mfma_f32_16x16x32_bf16 v[116:119], v[176:179], v[56:59], v[116:119]
    ds_read_b128 v[156:159], v188 offset:7168
    v_mfma_f32_16x16x32_bf16 v[120:123], v[180:183], v[56:59], v[120:123]
    ds_read_b128 v[160:163], v188 offset:8192
    v_mfma_f32_16x16x32_bf16 v[124:127], v[184:187], v[56:59], v[124:127]
    ds_read_b128 v[164:167], v188 offset:9216
    s_waitcnt lgkmcnt(5)
    s_waitcnt vmcnt(11)
    v_mfma_f32_16x16x32_bf16 v[108:111], v[128:131], v[60:63], v[108:111]
    ds_read_b128 v[168:171], v188 offset:10240
    v_mfma_f32_16x16x32_bf16 v[112:115], v[132:135], v[60:63], v[112:115]
    ds_read_b128 v[172:175], v188 offset:11264
    s_add_u32 s79, s81, s80
    s_add_u32 s15, s79, 4096
    buffer_load_dwordx4 v[36:39], v3, s[60:63], s79 offen offset:0 sc1
    v_mfma_f32_16x16x32_bf16 v[116:119], v[136:139], v[60:63], v[116:119]
    ds_read_b128 v[176:179], v188 offset:12288
    v_mfma_f32_16x16x32_bf16 v[120:123], v[140:143], v[60:63], v[120:123]
    ds_read_b128 v[180:183], v188 offset:13312
    v_mfma_f32_16x16x32_bf16 v[124:127], v[144:147], v[60:63], v[124:127]
    ds_read_b128 v[184:187], v188 offset:14336
    s_waitcnt lgkmcnt(5)
    s_waitcnt vmcnt(11)
    v_mfma_f32_16x16x32_bf16 v[108:111], v[148:151], v[64:67], v[108:111]
    ds_read_b128 v[128:131], v188 offset:15360
    v_mfma_f32_16x16x32_bf16 v[112:115], v[152:155], v[64:67], v[112:115]
    ds_read_b128 v[132:135], v188 offset:16384
    buffer_load_dwordx4 v[40:43], v3, s[60:63], s79 offen offset:1024 sc1
    v_mfma_f32_16x16x32_bf16 v[116:119], v[156:159], v[64:67], v[116:119]
    ds_read_b128 v[136:139], v188 offset:17408
    v_mfma_f32_16x16x32_bf16 v[120:123], v[160:163], v[64:67], v[120:123]
    ds_read_b128 v[140:143], v188 offset:18432
    v_mfma_f32_16x16x32_bf16 v[124:127], v[164:167], v[64:67], v[124:127]
    ds_read_b128 v[144:147], v188 offset:19456
    s_waitcnt lgkmcnt(5)
    s_waitcnt vmcnt(11)
    v_mfma_f32_16x16x32_bf16 v[108:111], v[168:171], v[76:79], v[108:111]
    ds_read_b128 v[148:151], v188 offset:20480
    v_mfma_f32_16x16x32_bf16 v[112:115], v[172:175], v[76:79], v[112:115]
    ds_read_b128 v[152:155], v188 offset:21504
    buffer_load_dwordx4 v[52:55], v3, s[60:63], s15 offen offset:0 sc1
    v_mfma_f32_16x16x32_bf16 v[116:119], v[176:179], v[76:79], v[116:119]
    ds_read_b128 v[156:159], v188 offset:22528
    v_mfma_f32_16x16x32_bf16 v[120:123], v[180:183], v[76:79], v[120:123]
    ds_read_b128 v[160:163], v188 offset:23552
    v_mfma_f32_16x16x32_bf16 v[124:127], v[184:187], v[76:79], v[124:127]
    ds_read_b128 v[164:167], v188 offset:24576
    s_waitcnt lgkmcnt(5)
    s_waitcnt vmcnt(11)
    v_mfma_f32_16x16x32_bf16 v[108:111], v[128:131], v[68:71], v[108:111]
    ds_read_b128 v[168:171], v188 offset:25600
    v_mfma_f32_16x16x32_bf16 v[112:115], v[132:135], v[68:71], v[112:115]
    ds_read_b128 v[172:175], v188 offset:26624
    buffer_load_dwordx4 v[44:47], v3, s[60:63], s79 offen offset:2048 sc1
    v_mfma_f32_16x16x32_bf16 v[116:119], v[136:139], v[68:71], v[116:119]
    ds_read_b128 v[176:179], v188 offset:27648
    v_mfma_f32_16x16x32_bf16 v[120:123], v[140:143], v[68:71], v[120:123]
    ds_read_b128 v[180:183], v188 offset:28672
    v_mfma_f32_16x16x32_bf16 v[124:127], v[144:147], v[68:71], v[124:127]
    ds_read_b128 v[184:187], v188 offset:29696
    s_waitcnt lgkmcnt(5)
    s_waitcnt vmcnt(11)
    s_barrier
    v_add_u32 v189, 0, v3
    v_mfma_f32_16x16x32_bf16 v[108:111], v[148:151], v[72:75], v[108:111]
    ds_read_b128 v[128:131], v189 offset:0
    v_mfma_f32_16x16x32_bf16 v[112:115], v[152:155], v[72:75], v[112:115]
    ds_read_b128 v[132:135], v189 offset:1024
    buffer_load_dwordx4 v[48:51], v3, s[60:63], s79 offen offset:3072 sc1
    v_mfma_f32_16x16x32_bf16 v[116:119], v[156:159], v[72:75], v[116:119]
    ds_read_b128 v[136:139], v189 offset:2048
    v_mfma_f32_16x16x32_bf16 v[120:123], v[160:163], v[72:75], v[120:123]
    ds_read_b128 v[140:143], v189 offset:3072
    v_mfma_f32_16x16x32_bf16 v[124:127], v[164:167], v[72:75], v[124:127]
    ds_read_b128 v[144:147], v189 offset:4096
    s_waitcnt lgkmcnt(5)
    s_waitcnt vmcnt(11)
    v_mfma_f32_16x16x32_bf16 v[108:111], v[168:171], v[80:83], v[108:111]
    ds_read_b128 v[148:151], v189 offset:5120
    v_mfma_f32_16x16x32_bf16 v[112:115], v[172:175], v[80:83], v[112:115]
    ds_read_b128 v[152:155], v189 offset:6144
    buffer_load_dwordx4 v[56:59], v3, s[60:63], s15 offen offset:1024 sc1
    s_add_u32 s80, s80, 6144
    s_cmp_eq_u32 s80, 49152
    s_cselect_b32 s80, 0, s80
    v_mfma_f32_16x16x32_bf16 v[116:119], v[176:179], v[80:83], v[116:119]
    ds_read_b128 v[156:159], v189 offset:7168
    v_mfma_f32_16x16x32_bf16 v[120:123], v[180:183], v[80:83], v[120:123]
    ds_read_b128 v[160:163], v189 offset:8192
    v_mfma_f32_16x16x32_bf16 v[124:127], v[184:187], v[80:83], v[124:127]
    ds_read_b128 v[164:167], v189 offset:9216
    s_waitcnt lgkmcnt(5)
    s_waitcnt vmcnt(11)
    v_mfma_f32_16x16x32_bf16 v[108:111], v[128:131], v[84:87], v[108:111]
    ds_read_b128 v[168:171], v189 offset:10240
    v_mfma_f32_16x16x32_bf16 v[112:115], v[132:135], v[84:87], v[112:115]
    ds_read_b128 v[172:175], v189 offset:11264
    s_add_u32 s79, s81, s80
    s_add_u32 s15, s79, 4096
    buffer_load_dwordx4 v[60:63], v3, s[60:63], s79 offen offset:0 sc1
    v_mfma_f32_16x16x32_bf16 v[116:119], v[136:139], v[84:87], v[116:119]
    ds_read_b128 v[176:179], v189 offset:12288
    v_mfma_f32_16x16x32_bf16 v[120:123], v[140:143], v[84:87], v[120:123]
    ds_read_b128 v[180:183], v189 offset:13312
    v_mfma_f32_16x16x32_bf16 v[124:127], v[144:147], v[84:87], v[124:127]
    ds_read_b128 v[184:187], v189 offset:14336
    s_waitcnt lgkmcnt(5)
    s_waitcnt vmcnt(11)
    v_mfma_f32_16x16x32_bf16 v[108:111], v[148:151], v[88:91], v[108:111]
    ds_read_b128 v[128:131], v189 offset:15360
    v_mfma_f32_16x16x32_bf16 v[112:115], v[152:155], v[88:91], v[112:115]
    ds_read_b128 v[132:135], v189 offset:16384
    buffer_load_dwordx4 v[64:67], v3, s[60:63], s79 offen offset:1024 sc1
    v_mfma_f32_16x16x32_bf16 v[116:119], v[156:159], v[88:91], v[116:119]
    ds_read_b128 v[136:139], v189 offset:17408
    v_mfma_f32_16x16x32_bf16 v[120:123], v[160:163], v[88:91], v[120:123]
    ds_read_b128 v[140:143], v189 offset:18432
    v_mfma_f32_16x16x32_bf16 v[124:127], v[164:167], v[88:91], v[124:127]
    ds_read_b128 v[144:147], v189 offset:19456
    s_waitcnt lgkmcnt(5)
    s_waitcnt vmcnt(11)
    v_mfma_f32_16x16x32_bf16 v[108:111], v[168:171], v[100:103], v[108:111]
    ds_read_b128 v[148:151], v189 offset:20480
    v_mfma_f32_16x16x32_bf16 v[112:115], v[172:175], v[100:103], v[112:115]
    ds_read_b128 v[152:155], v189 offset:21504
    buffer_load_dwordx4 v[76:79], v3, s[60:63], s15 offen offset:0 sc1
    v_mfma_f32_16x16x32_bf16 v[116:119], v[176:179], v[100:103], v[116:119]
    ds_read_b128 v[156:159], v189 offset:22528
    v_mfma_f32_16x16x32_bf16 v[120:123], v[180:183], v[100:103], v[120:123]
    ds_read_b128 v[160:163], v189 offset:23552
    v_mfma_f32_16x16x32_bf16 v[124:127], v[184:187], v[100:103], v[124:127]
    ds_read_b128 v[164:167], v189 offset:24576
    s_waitcnt lgkmcnt(5)
    s_waitcnt vmcnt(11)
    v_mfma_f32_16x16x32_bf16 v[108:111], v[128:131], v[92:95], v[108:111]
    ds_read_b128 v[168:171], v189 offset:25600
    v_mfma_f32_16x16x32_bf16 v[112:115], v[132:135], v[92:95], v[112:115]
    ds_read_b128 v[172:175], v189 offset:26624
    buffer_load_dwordx4 v[68:71], v3, s[60:63], s79 offen offset:2048 sc1
    v_mfma_f32_16x16x32_bf16 v[116:119], v[136:139], v[92:95], v[116:119]
    ds_read_b128 v[176:179], v189 offset:27648
    v_mfma_f32_16x16x32_bf16 v[120:123], v[140:143], v[92:95], v[120:123]
    ds_read_b128 v[180:183], v189 offset:28672
    v_mfma_f32_16x16x32_bf16 v[124:127], v[144:147], v[92:95], v[124:127]
    ds_read_b128 v[184:187], v189 offset:29696
    s_waitcnt lgkmcnt(5)
    s_waitcnt vmcnt(11)
    s_barrier
    v_add_u32 v188, 30720, v3
    v_mfma_f32_16x16x32_bf16 v[108:111], v[148:151], v[96:99], v[108:111]
    ds_read_b128 v[128:131], v188 offset:0
    v_mfma_f32_16x16x32_bf16 v[112:115], v[152:155], v[96:99], v[112:115]
    ds_read_b128 v[132:135], v188 offset:1024
    buffer_load_dwordx4 v[72:75], v3, s[60:63], s79 offen offset:3072 sc1
    v_mfma_f32_16x16x32_bf16 v[116:119], v[156:159], v[96:99], v[116:119]
    ds_read_b128 v[136:139], v188 offset:2048
    v_mfma_f32_16x16x32_bf16 v[120:123], v[160:163], v[96:99], v[120:123]
    ds_read_b128 v[140:143], v188 offset:3072
    v_mfma_f32_16x16x32_bf16 v[124:127], v[164:167], v[96:99], v[124:127]
    ds_read_b128 v[144:147], v188 offset:4096
    s_waitcnt lgkmcnt(5)
    s_waitcnt vmcnt(11)
    v_mfma_f32_16x16x32_bf16 v[108:111], v[168:171], v[104:107], v[108:111]
    ds_read_b128 v[148:151], v188 offset:5120
    v_mfma_f32_16x16x32_bf16 v[112:115], v[172:175], v[104:107], v[112:115]
    ds_read_b128 v[152:155], v188 offset:6144
    buffer_load_dwordx4 v[80:83], v3, s[60:63], s15 offen offset:1024 sc1
    s_add_u32 s80, s80, 6144
    s_cmp_eq_u32 s80, 49152
    s_cselect_b32 s80, 0, s80
    v_mfma_f32_16x16x32_bf16 v[116:119], v[176:179], v[104:107], v[116:119]
    ds_read_b128 v[156:159], v188 offset:7168
    v_mfma_f32_16x16x32_bf16 v[120:123], v[180:183], v[104:107], v[120:123]
    ds_read_b128 v[160:163], v188 offset:8192
    v_mfma_f32_16x16x32_bf16 v[124:127], v[184:187], v[104:107], v[124:127]
    ds_read_b128 v[164:167], v188 offset:9216
    s_waitcnt lgkmcnt(5)
    s_waitcnt vmcnt(11)
    v_mfma_f32_16x16x32_bf16 v[108:111], v[128:131], v[36:39], v[108:111]
    ds_read_b128 v[168:171], v188 offset:10240
    v_mfma_f32_16x16x32_bf16 v[112:115], v[132:135], v[36:39], v[112:115]
    ds_read_b128 v[172:175], v188 offset:11264
    v_mfma_f32_16x16x32_bf16 v[116:119], v[136:139], v[36:39], v[116:119]
    ds_read_b128 v[176:179], v188 offset:12288
    v_mfma_f32_16x16x32_bf16 v[120:123], v[140:143], v[36:39], v[120:123]
    ds_read_b128 v[180:183], v188 offset:13312
    v_mfma_f32_16x16x32_bf16 v[124:127], v[144:147], v[36:39], v[124:127]
    ds_read_b128 v[184:187], v188 offset:14336
    s_waitcnt lgkmcnt(5)
    s_waitcnt vmcnt(10)
    v_mfma_f32_16x16x32_bf16 v[108:111], v[148:151], v[40:43], v[108:111]
    ds_read_b128 v[128:131], v188 offset:15360
    v_mfma_f32_16x16x32_bf16 v[112:115], v[152:155], v[40:43], v[112:115]
    ds_read_b128 v[132:135], v188 offset:16384
    v_mfma_f32_16x16x32_bf16 v[116:119], v[156:159], v[40:43], v[116:119]
    ds_read_b128 v[136:139], v188 offset:17408
    v_mfma_f32_16x16x32_bf16 v[120:123], v[160:163], v[40:43], v[120:123]
    ds_read_b128 v[140:143], v188 offset:18432
    v_mfma_f32_16x16x32_bf16 v[124:127], v[164:167], v[40:43], v[124:127]
    ds_read_b128 v[144:147], v188 offset:19456
    s_waitcnt lgkmcnt(5)
    s_waitcnt vmcnt(9)
    v_mfma_f32_16x16x32_bf16 v[108:111], v[168:171], v[52:55], v[108:111]
    ds_read_b128 v[148:151], v188 offset:20480
    v_mfma_f32_16x16x32_bf16 v[112:115], v[172:175], v[52:55], v[112:115]
    ds_read_b128 v[152:155], v188 offset:21504
    v_mfma_f32_16x16x32_bf16 v[116:119], v[176:179], v[52:55], v[116:119]
    ds_read_b128 v[156:159], v188 offset:22528
    v_mfma_f32_16x16x32_bf16 v[120:123], v[180:183], v[52:55], v[120:123]
    ds_read_b128 v[160:163], v188 offset:23552
    v_mfma_f32_16x16x32_bf16 v[124:127], v[184:187], v[52:55], v[124:127]
    ds_read_b128 v[164:167], v188 offset:24576
    s_waitcnt lgkmcnt(5)
    s_waitcnt vmcnt(8)
    v_mfma_f32_16x16x32_bf16 v[108:111], v[128:131], v[44:47], v[108:111]
    ds_read_b128 v[168:171], v188 offset:25600
    v_mfma_f32_16x16x32_bf16 v[112:115], v[132:135], v[44:47], v[112:115]
    ds_read_b128 v[172:175], v188 offset:26624
    v_mfma_f32_16x16x32_bf16 v[116:119], v[136:139], v[44:47], v[116:119]
    ds_read_b128 v[176:179], v188 offset:27648
    v_mfma_f32_16x16x32_bf16 v[120:123], v[140:143], v[44:47], v[120:123]
    ds_read_b128 v[180:183], v188 offset:28672
    v_mfma_f32_16x16x32_bf16 v[124:127], v[144:147], v[44:47], v[124:127]
    ds_read_b128 v[184:187], v188 offset:29696
    s_waitcnt lgkmcnt(5)
    s_waitcnt vmcnt(7)
    s_barrier
    v_add_u32 v189, 61440, v3
    v_mfma_f32_16x16x32_bf16 v[108:111], v[148:151], v[48:51], v[108:111]
    ds_read_b128 v[128:131], v189 offset:0
    v_mfma_f32_16x16x32_bf16 v[112:115], v[152:155], v[48:51], v[112:115]
    ds_read_b128 v[132:135], v189 offset:1024
    v_mfma_f32_16x16x32_bf16 v[116:119], v[156:159], v[48:51], v[116:119]
    ds_read_b128 v[136:139], v189 offset:2048
    v_mfma_f32_16x16x32_bf16 v[120:123], v[160:163], v[48:51], v[120:123]
    ds_read_b128 v[140:143], v189 offset:3072
    v_mfma_f32_16x16x32_bf16 v[124:127], v[164:167], v[48:51], v[124:127]
    ds_read_b128 v[144:147], v189 offset:4096
    s_waitcnt lgkmcnt(5)
    s_waitcnt vmcnt(6)
    v_mfma_f32_16x16x32_bf16 v[108:111], v[168:171], v[56:59], v[108:111]
    ds_read_b128 v[148:151], v189 offset:5120
    v_mfma_f32_16x16x32_bf16 v[112:115], v[172:175], v[56:59], v[112:115]
    ds_read_b128 v[152:155], v189 offset:6144
    v_mfma_f32_16x16x32_bf16 v[116:119], v[176:179], v[56:59], v[116:119]
    ds_read_b128 v[156:159], v189 offset:7168
    v_mfma_f32_16x16x32_bf16 v[120:123], v[180:183], v[56:59], v[120:123]
    ds_read_b128 v[160:163], v189 offset:8192
    v_mfma_f32_16x16x32_bf16 v[124:127], v[184:187], v[56:59], v[124:127]
    ds_read_b128 v[164:167], v189 offset:9216
    s_waitcnt lgkmcnt(5)
    s_waitcnt vmcnt(5)
    v_mfma_f32_16x16x32_bf16 v[108:111], v[128:131], v[60:63], v[108:111]
    ds_read_b128 v[168:171], v189 offset:10240
    v_mfma_f32_16x16x32_bf16 v[112:115], v[132:135], v[60:63], v[112:115]
    ds_read_b128 v[172:175], v189 offset:11264
    v_mfma_f32_16x16x32_bf16 v[116:119], v[136:139], v[60:63], v[116:119]
    ds_read_b128 v[176:179], v189 offset:12288
    v_mfma_f32_16x16x32_bf16 v[120:123], v[140:143], v[60:63], v[120:123]
    ds_read_b128 v[180:183], v189 offset:13312
    v_mfma_f32_16x16x32_bf16 v[124:127], v[144:147], v[60:63], v[124:127]
    ds_read_b128 v[184:187], v189 offset:14336
    s_waitcnt lgkmcnt(5)
    s_waitcnt vmcnt(4)
    v_mfma_f32_16x16x32_bf16 v[108:111], v[148:151], v[64:67], v[108:111]
    ds_read_b128 v[128:131], v189 offset:15360
    v_mfma_f32_16x16x32_bf16 v[112:115], v[152:155], v[64:67], v[112:115]
    ds_read_b128 v[132:135], v189 offset:16384
    v_mfma_f32_16x16x32_bf16 v[116:119], v[156:159], v[64:67], v[116:119]
    ds_read_b128 v[136:139], v189 offset:17408
    v_mfma_f32_16x16x32_bf16 v[120:123], v[160:163], v[64:67], v[120:123]
    ds_read_b128 v[140:143], v189 offset:18432
    v_mfma_f32_16x16x32_bf16 v[124:127], v[164:167], v[64:67], v[124:127]
    ds_read_b128 v[144:147], v189 offset:19456
    s_waitcnt lgkmcnt(5)
    s_waitcnt vmcnt(3)
    v_mfma_f32_16x16x32_bf16 v[108:111], v[168:171], v[76:79], v[108:111]
    ds_read_b128 v[148:151], v189 offset:20480
    v_mfma_f32_16x16x32_bf16 v[112:115], v[172:175], v[76:79], v[112:115]
    ds_read_b128 v[152:155], v189 offset:21504
    v_mfma_f32_16x16x32_bf16 v[116:119], v[176:179], v[76:79], v[116:119]
    ds_read_b128 v[156:159], v189 offset:22528
    v_mfma_f32_16x16x32_bf16 v[120:123], v[180:183], v[76:79], v[120:123]
    ds_read_b128 v[160:163], v189 offset:23552
    v_mfma_f32_16x16x32_bf16 v[124:127], v[184:187], v[76:79], v[124:127]
    ds_read_b128 v[164:167], v189 offset:24576
    s_waitcnt lgkmcnt(5)
    s_waitcnt vmcnt(2)
    v_mfma_f32_16x16x32_bf16 v[108:111], v[128:131], v[68:71], v[108:111]
    ds_read_b128 v[168:171], v189 offset:25600
    v_mfma_f32_16x16x32_bf16 v[112:115], v[132:135], v[68:71], v[112:115]
    ds_read_b128 v[172:175], v189 offset:26624
    v_mfma_f32_16x16x32_bf16 v[116:119], v[136:139], v[68:71], v[116:119]
    ds_read_b128 v[176:179], v189 offset:27648
    v_mfma_f32_16x16x32_bf16 v[120:123], v[140:143], v[68:71], v[120:123]
    ds_read_b128 v[180:183], v189 offset:28672
    v_mfma_f32_16x16x32_bf16 v[124:127], v[144:147], v[68:71], v[124:127]
    ds_read_b128 v[184:187], v189 offset:29696
    s_waitcnt lgkmcnt(5)
    s_waitcnt vmcnt(1)
    v_mfma_f32_16x16x32_bf16 v[108:111], v[148:151], v[72:75], v[108:111]
    v_mfma_f32_16x16x32_bf16 v[112:115], v[152:155], v[72:75], v[112:115]
    v_mfma_f32_16x16x32_bf16 v[116:119], v[156:159], v[72:75], v[116:119]
    v_mfma_f32_16x16x32_bf16 v[120:123], v[160:163], v[72:75], v[120:123]
    v_mfma_f32_16x16x32_bf16 v[124:127], v[164:167], v[72:75], v[124:127]
    s_waitcnt lgkmcnt(0)
    s_waitcnt vmcnt(0)
    v_mfma_f32_16x16x32_bf16 v[108:111], v[168:171], v[80:83], v[108:111]
    v_mfma_f32_16x16x32_bf16 v[112:115], v[172:175], v[80:83], v[112:115]
    v_mfma_f32_16x16x32_bf16 v[116:119], v[176:179], v[80:83], v[116:119]
    v_mfma_f32_16x16x32_bf16 v[120:123], v[180:183], v[80:83], v[120:123]
    v_mfma_f32_16x16x32_bf16 v[124:127], v[184:187], v[80:83], v[124:127]
    s_mov_b32 s11, 0xffff0000
    s_lshl_b32 s10, s5, 6
    s_lshl_b32 s12, s9, 4
    s_add_u32 s10, s10, s12
    s_mul_i32 s10, s10, 1280
    s_mul_i32 s12, s6, 160
    s_add_u32 s10, s10, s12
    v_mul_u32_u24 v27, 1280, v1
    v_lshl_add_u32 v27, v2, 3, v27
    v_lshlrev_b32 v20, 16, v8
    v_and_b32 v21, s11, v8
    v_lshlrev_b32 v22, 16, v190
    v_and_b32 v23, s11, v190
    v_pk_add_f32 v[20:21], v[20:21], v[22:23]
    v_pk_add_f32 v[20:21], v[20:21], v[108:109]
    v_cvt_pk_bf16_f32 v8, v20, v21
    v_lshlrev_b32 v20, 16, v9
    v_and_b32 v21, s11, v9
    v_lshlrev_b32 v22, 16, v191
    v_and_b32 v23, s11, v191
    v_pk_add_f32 v[20:21], v[20:21], v[22:23]
    v_pk_add_f32 v[20:21], v[20:21], v[110:111]
    v_cvt_pk_bf16_f32 v9, v20, v21
    buffer_store_dwordx2 v[8:9], v27, s[64:67], s10 offen offset:0
    v_lshlrev_b32 v20, 16, v10
    v_and_b32 v21, s11, v10
    v_lshlrev_b32 v22, 16, v192
    v_and_b32 v23, s11, v192
    v_pk_add_f32 v[20:21], v[20:21], v[22:23]
    v_pk_add_f32 v[20:21], v[20:21], v[112:113]
    v_cvt_pk_bf16_f32 v10, v20, v21
    v_lshlrev_b32 v20, 16, v11
    v_and_b32 v21, s11, v11
    v_lshlrev_b32 v22, 16, v193
    v_and_b32 v23, s11, v193
    v_pk_add_f32 v[20:21], v[20:21], v[22:23]
    v_pk_add_f32 v[20:21], v[20:21], v[114:115]
    v_cvt_pk_bf16_f32 v11, v20, v21
    buffer_store_dwordx2 v[10:11], v27, s[64:67], s10 offen offset:32
    v_lshlrev_b32 v20, 16, v12
    v_and_b32 v21, s11, v12
    v_lshlrev_b32 v22, 16, v194
    v_and_b32 v23, s11, v194
    v_pk_add_f32 v[20:21], v[20:21], v[22:23]
    v_pk_add_f32 v[20:21], v[20:21], v[116:117]
    v_cvt_pk_bf16_f32 v12, v20, v21
    v_lshlrev_b32 v20, 16, v13
    v_and_b32 v21, s11, v13
    v_lshlrev_b32 v22, 16, v195
    v_and_b32 v23, s11, v195
    v_pk_add_f32 v[20:21], v[20:21], v[22:23]
    v_pk_add_f32 v[20:21], v[20:21], v[118:119]
    v_cvt_pk_bf16_f32 v13, v20, v21
    buffer_store_dwordx2 v[12:13], v27, s[64:67], s10 offen offset:64
    v_lshlrev_b32 v20, 16, v14
    v_and_b32 v21, s11, v14
    v_lshlrev_b32 v22, 16, v196
    v_and_b32 v23, s11, v196
    v_pk_add_f32 v[20:21], v[20:21], v[22:23]
    v_pk_add_f32 v[20:21], v[20:21], v[120:121]
    v_cvt_pk_bf16_f32 v14, v20, v21
    v_lshlrev_b32 v20, 16, v15
    v_and_b32 v21, s11, v15
    v_lshlrev_b32 v22, 16, v197
    v_and_b32 v23, s11, v197
    v_pk_add_f32 v[20:21], v[20:21], v[22:23]
    v_pk_add_f32 v[20:21], v[20:21], v[122:123]
    v_cvt_pk_bf16_f32 v15, v20, v21
    buffer_store_dwordx2 v[14:15], v27, s[64:67], s10 offen offset:96
    v_lshlrev_b32 v20, 16, v16
    v_and_b32 v21, s11, v16
    v_lshlrev_b32 v22, 16, v198
    v_and_b32 v23, s11, v198
    v_pk_add_f32 v[20:21], v[20:21], v[22:23]
    v_pk_add_f32 v[20:21], v[20:21], v[124:125]
    v_cvt_pk_bf16_f32 v16, v20, v21
    v_lshlrev_b32 v20, 16, v17
    v_and_b32 v21, s11, v17
    v_lshlrev_b32 v22, 16, v199
    v_and_b32 v23, s11, v199
    v_pk_add_f32 v[20:21], v[20:21], v[22:23]
    v_pk_add_f32 v[20:21], v[20:21], v[126:127]
    v_cvt_pk_bf16_f32 v17, v20, v21
    buffer_store_dwordx2 v[16:17], v27, s[64:67], s10 offen offset:128
    s_endpgm
L_loader:
    v_lshrrev_b32 v24, 3, v0
    v_and_b32 v25, 7, v0
    v_and_b32 v26, 6, v24
    v_xor_b32 v25, v25, v26
    v_mul_u32_u24 v24, 1280, v24
    v_lshl_add_u32 v4, v25, 4, v24
    s_lshl_b32 s10, s5, 6
    s_lshl_b32 s11, s9, 4
    s_add_u32 s10, s10, s11
    s_mul_i32 s79, s10, 1280
    s_and_b32 s10, s9, 1
    s_add_u32 s11, s10, 1
    s_mul_i32 s11, s11, 1280
    s_mul_i32 s12, s6, 160
    s_add_u32 s80, s11, s12
    s_lshr_b32 s11, s9, 1
    s_mul_i32 s12, s11, 122880
    s_add_u32 s80, s80, s12
    s_mul_i32 s13, s10, 5120
    s_mul_i32 s11, s11, 10240
    s_add_u32 s13, s13, s11
    s_add_u32 s13, s13, 81920
    s_lshl_b32 s14, s9, 11
    s_mov_b32 s77, 0
    s_mov_b32 s76, s39
    s_mov_b32 s82, s39
    v_add_u32 v24, 0, v0
    v_mul_u32_u24 v25, 6554, v24
    v_lshrrev_b32 v25, 16, v25
    v_mul_u32_u24 v26, 10, v25
    v_sub_u32 v26, v24, v26
    v_lshlrev_b32 v26, 4, v26
    v_bfe_u32 v27, v25, 2, 2
    v_lshlrev_b32 v27, 3, v27
    v_and_b32 v28, 3, v25
    v_add_u32 v27, v27, v28
    v_lshrrev_b32 v28, 4, v25
    v_lshl_add_u32 v27, v28, 2, v27
    v_mul_u32_u24 v27, 3840, v27
    v_add_u32 v6, v27, v26
    v_add_u32 v24, 64, v0
    v_mul_u32_u24 v25, 6554, v24
    v_lshrrev_b32 v25, 16, v25
    v_mul_u32_u24 v26, 10, v25
    v_sub_u32 v26, v24, v26
    v_lshlrev_b32 v26, 4, v26
    v_subrev_u32 v26, 1024, v26
    v_bfe_u32 v27, v25, 2, 2
    v_lshlrev_b32 v27, 3, v27
    v_and_b32 v28, 3, v25
    v_add_u32 v27, v27, v28
    v_lshrrev_b32 v28, 4, v25
    v_lshl_add_u32 v27, v28, 2, v27
    v_mul_u32_u24 v27, 3840, v27
    v_add_u32 v7, v27, v26
    v_add_u32 v24, 128, v0
    v_mul_u32_u24 v25, 6554, v24
    v_lshrrev_b32 v25, 16, v25
    v_mul_u32_u24 v26, 10, v25
    v_sub_u32 v26, v24, v26
    v_lshlrev_b32 v26, 4, v26
    v_subrev_u32 v26, 2048, v26
    v_bfe_u32 v27, v25, 2, 2
    v_lshlrev_b32 v27, 3, v27
    v_and_b32 v28, 3, v25
    v_add_u32 v27, v27, v28
    v_lshrrev_b32 v28, 4, v25
    v_lshl_add_u32 v27, v28, 2, v27
    v_mul_u32_u24 v27, 3840, v27
    v_add_u32 v8, v27, v26
    v_add_u32 v24, 192, v0
    v_mul_u32_u24 v25, 6554, v24
    v_lshrrev_b32 v25, 16, v25
    v_mul_u32_u24 v26, 10, v25
    v_sub_u32 v26, v24, v26
    v_lshlrev_b32 v26, 4, v26
    v_subrev_u32 v26, 3072, v26
    v_bfe_u32 v27, v25, 2, 2
    v_lshlrev_b32 v27, 3, v27
    v_and_b32 v28, 3, v25
    v_add_u32 v27, v27, v28
    v_lshrrev_b32 v28, 4, v25
    v_lshl_add_u32 v27, v28, 2, v27
    v_mul_u32_u24 v27, 3840, v27
    v_add_u32 v9, v27, v26
    v_add_u32 v24, 256, v0
    v_mul_u32_u24 v25, 6554, v24
    v_lshrrev_b32 v25, 16, v25
    v_mul_u32_u24 v26, 10, v25
    v_sub_u32 v26, v24, v26
    v_lshlrev_b32 v26, 4, v26
    v_bfe_u32 v27, v25, 2, 2
    v_lshlrev_b32 v27, 3, v27
    v_and_b32 v28, 3, v25
    v_add_u32 v27, v27, v28
    v_lshrrev_b32 v28, 4, v25
    v_lshl_add_u32 v27, v28, 2, v27
    v_mul_u32_u24 v27, 3840, v27
    v_add_u32 v10, v27, v26
    s_waitcnt lgkmcnt(0)
    s_mov_b32 s40, s16
    s_mov_b32 s41, s17
    s_mov_b32 s42, 2621440
    s_mov_b32 s43, 0x00020000
    s_mov_b32 s44, s18
    s_mov_b32 s45, s19
    s_mov_b32 s46, 2457600
    s_mov_b32 s47, 0x00020000
    s_lshl_b32 s11, s76, 7
    s_add_u32 s11, s11, s79
    s_lshl_b32 s12, s76, 13
    s_add_u32 s12, s12, s14
    s_add_u32 m0, s12, 0
    s_add_u32 s12, s11, 9216
    buffer_load_dwordx4 v4, s[40:43], s11 offen lds
    buffer_load_dwordx4 v4, s[40:43], s12 offen offset:1024 lds
    s_add_u32 s76, s76, 1
    s_cmp_eq_u32 s76, 10
    s_cselect_b32 s76, 0, s76
    s_mul_i32 s11, s82, 245760
    s_add_u32 s12, s77, s13
    s_add_u32 m0, s12, 0
    s_add_u32 s11, s11, s80
    buffer_load_dwordx4 v6, s[44:47], s11 offen lds
    buffer_load_dwordx4 v7, s[44:47], s11 offen offset:1024 lds
    buffer_load_dwordx4 v8, s[44:47], s11 offen offset:2048 lds
    buffer_load_dwordx4 v9, s[44:47], s11 offen offset:3072 lds
    s_add_u32 m0, m0, 4096
    s_nop 0
    buffer_load_dwordx4 v10, s[44:47], s11 offen lds
    s_add_u32 s82, s82, 1
    s_cmp_eq_u32 s82, 10
    s_cselect_b32 s82, 0, s82
    s_add_u32 s77, s77, 20480
    s_cmp_eq_u32 s77, 61440
    s_cselect_b32 s77, 0, s77
    s_lshl_b32 s11, s76, 7
    s_add_u32 s11, s11, s79
    s_lshl_b32 s12, s76, 13
    s_add_u32 s12, s12, s14
    s_add_u32 m0, s12, 0
    s_add_u32 s12, s11, 9216
    buffer_load_dwordx4 v4, s[40:43], s11 offen lds
    buffer_load_dwordx4 v4, s[40:43], s12 offen offset:1024 lds
    s_add_u32 s76, s76, 1
    s_cmp_eq_u32 s76, 10
    s_cselect_b32 s76, 0, s76
    s_mul_i32 s11, s82, 245760
    s_add_u32 s12, s77, s13
    s_add_u32 m0, s12, 0
    s_add_u32 s11, s11, s80
    buffer_load_dwordx4 v6, s[44:47], s11 offen lds
    buffer_load_dwordx4 v7, s[44:47], s11 offen offset:1024 lds
    buffer_load_dwordx4 v8, s[44:47], s11 offen offset:2048 lds
    buffer_load_dwordx4 v9, s[44:47], s11 offen offset:3072 lds
    s_add_u32 m0, m0, 4096
    s_nop 0
    buffer_load_dwordx4 v10, s[44:47], s11 offen lds
    s_add_u32 s82, s82, 1
    s_cmp_eq_u32 s82, 10
    s_cselect_b32 s82, 0, s82
    s_add_u32 s77, s77, 20480
    s_cmp_eq_u32 s77, 61440
    s_cselect_b32 s77, 0, s77
    s_load_dword s7, s[36:37], 0
    s_waitcnt vmcnt(7)
    s_barrier
    s_lshl_b32 s11, s76, 7
    s_add_u32 s11, s11, s79
    s_lshl_b32 s12, s76, 13
    s_add_u32 s12, s12, s14
    s_add_u32 m0, s12, 0
    s_add_u32 s12, s11, 9216
    buffer_load_dwordx4 v4, s[40:43], s11 offen lds
    buffer_load_dwordx4 v4, s[40:43], s12 offen offset:1024 lds
    s_add_u32 s76, s76, 1
    s_cmp_eq_u32 s76, 10
    s_cselect_b32 s76, 0, s76
    s_mul_i32 s11, s82, 245760
    s_add_u32 s12, s77, s13
    s_add_u32 m0, s12, 0
    s_add_u32 s11, s11, s80
    buffer_load_dwordx4 v6, s[44:47], s11 offen lds
    buffer_load_dwordx4 v7, s[44:47], s11 offen offset:1024 lds
    buffer_load_dwordx4 v8, s[44:47], s11 offen offset:2048 lds
    buffer_load_dwordx4 v9, s[44:47], s11 offen offset:3072 lds
    s_add_u32 m0, m0, 4096
    s_nop 0
    buffer_load_dwordx4 v10, s[44:47], s11 offen lds
    s_add_u32 s82, s82, 1
    s_cmp_eq_u32 s82, 10
    s_cselect_b32 s82, 0, s82
    s_add_u32 s77, s77, 20480
    s_cmp_eq_u32 s77, 61440
    s_cselect_b32 s77, 0, s77
    s_lshl_b32 s11, s76, 7
    s_add_u32 s11, s11, s79
    s_lshl_b32 s12, s76, 13
    s_add_u32 s12, s12, s14
    s_add_u32 m0, s12, 0
    s_add_u32 s12, s11, 9216
    buffer_load_dwordx4 v4, s[40:43], s11 offen lds
    buffer_load_dwordx4 v4, s[40:43], s12 offen offset:1024 lds
    s_add_u32 s76, s76, 1
    s_cmp_eq_u32 s76, 10
    s_cselect_b32 s76, 0, s76
    s_lshl_b32 s11, s76, 7
    s_add_u32 s11, s11, s79
    s_lshl_b32 s12, s76, 13
    s_add_u32 s12, s12, s14
    s_add_u32 m0, s12, 0
    s_add_u32 s12, s11, 9216
    buffer_load_dwordx4 v4, s[40:43], s11 offen lds
    buffer_load_dwordx4 v4, s[40:43], s12 offen offset:1024 lds
    s_add_u32 s76, s76, 1
    s_cmp_eq_u32 s76, 10
    s_cselect_b32 s76, 0, s76
    v_lshlrev_b32 v2, 4, v0
    v_mov_b32 v3, 0
    v_lshlrev_b32 v34, 7, v0
    v_add_u32 v24, 0, v0
    v_mul_u32_u24 v25, 6554, v24
    v_lshrrev_b32 v25, 16, v25
    v_mul_u32_u24 v26, 10, v25
    v_sub_u32 v26, v24, v26
    v_lshlrev_b32 v26, 4, v26
    v_mul_u32_u24 v27, 1280, v25
    v_add_u32 v12, v27, v26
    v_add_u32 v24, 64, v0
    v_mul_u32_u24 v25, 6554, v24
    v_lshrrev_b32 v25, 16, v25
    v_mul_u32_u24 v26, 10, v25
    v_sub_u32 v26, v24, v26
    v_lshlrev_b32 v26, 4, v26
    v_subrev_u32 v26, 1024, v26
    v_mul_u32_u24 v27, 1280, v25
    v_add_u32 v13, v27, v26
    v_add_u32 v24, 128, v0
    v_mul_u32_u24 v25, 6554, v24
    v_lshrrev_b32 v25, 16, v25
    v_mul_u32_u24 v26, 10, v25
    v_sub_u32 v26, v24, v26
    v_lshlrev_b32 v26, 4, v26
    v_subrev_u32 v26, 2048, v26
    v_mul_u32_u24 v27, 1280, v25
    v_add_u32 v14, v27, v26
    v_add_u32 v24, 192, v0
    v_mul_u32_u24 v25, 6554, v24
    v_lshrrev_b32 v25, 16, v25
    v_mul_u32_u24 v26, 10, v25
    v_sub_u32 v26, v24, v26
    v_lshlrev_b32 v26, 4, v26
    v_subrev_u32 v26, 3072, v26
    v_mul_u32_u24 v27, 1280, v25
    v_add_u32 v15, v27, v26
    v_add_u32 v24, 256, v0
    v_mul_u32_u24 v25, 6554, v24
    v_lshrrev_b32 v25, 16, v25
    v_mul_u32_u24 v26, 10, v25
    v_sub_u32 v26, v24, v26
    v_lshlrev_b32 v26, 4, v26
    v_mul_u32_u24 v27, 1280, v25
    v_add_u32 v16, v27, v26
    s_waitcnt vmcnt(11)
    s_barrier
    s_mul_i32 s11, s82, 245760
    s_add_u32 s12, s77, s13
    s_add_u32 m0, s12, 0
    s_add_u32 s11, s11, s80
    buffer_load_dwordx4 v6, s[44:47], s11 offen lds
    buffer_load_dwordx4 v7, s[44:47], s11 offen offset:1024 lds
    buffer_load_dwordx4 v8, s[44:47], s11 offen offset:2048 lds
    buffer_load_dwordx4 v9, s[44:47], s11 offen offset:3072 lds
    s_add_u32 m0, m0, 4096
    s_nop 0
    buffer_load_dwordx4 v10, s[44:47], s11 offen lds
    s_add_u32 s82, s82, 1
    s_cmp_eq_u32 s82, 10
    s_cselect_b32 s82, 0, s82
    s_add_u32 s77, s77, 20480
    s_cmp_eq_u32 s77, 61440
    s_cselect_b32 s77, 0, s77
    s_lshl_b32 s11, s76, 7
    s_add_u32 s11, s11, s79
    s_lshl_b32 s12, s76, 13
    s_add_u32 s12, s12, s14
    s_add_u32 m0, s12, 0
    s_add_u32 s12, s11, 9216
    buffer_load_dwordx4 v4, s[40:43], s11 offen lds
    buffer_load_dwordx4 v4, s[40:43], s12 offen offset:1024 lds
    s_add_u32 s76, s76, 1
    s_cmp_eq_u32 s76, 10
    s_cselect_b32 s76, 0, s76
    s_lshl_b32 s11, s76, 7
    s_add_u32 s11, s11, s79
    s_lshl_b32 s12, s76, 13
    s_add_u32 s12, s12, s14
    s_add_u32 m0, s12, 0
    s_add_u32 s12, s11, 9216
    buffer_load_dwordx4 v4, s[40:43], s11 offen lds
    buffer_load_dwordx4 v4, s[40:43], s12 offen offset:1024 lds
    s_add_u32 s76, s76, 1
    s_cmp_eq_u32 s76, 10
    s_cselect_b32 s76, 0, s76
    v_add_u32 v24, 0, v0
    v_mul_u32_u24 v25, 2731, v24
    v_lshrrev_b32 v25, 16, v25
    v_mul_u32_u24 v26, 24, v25
    v_sub_u32 v26, v24, v26
    v_lshrrev_b32 v27, 1, v26
    v_bfe_u32 v28, v25, 1, 2
    v_sub_u32 v27, v27, v28
    v_cmp_gt_i32 vcc, 0, v27
    v_add_u32 v28, 12, v27
    s_nop 0
    v_cndmask_b32 v27, v27, v28, vcc
    v_and_b32 v26, 1, v26
    v_lshlrev_b32 v26, 4, v26
    v_lshl_add_u32 v26, v27, 5, v26
    v_mul_u32_u24 v25, 3072, v25
    v_add_u32 v18, v25, v26
    v_add_u32 v24, 64, v0
    v_mul_u32_u24 v25, 2731, v24
    v_lshrrev_b32 v25, 16, v25
    v_mul_u32_u24 v26, 24, v25
    v_sub_u32 v26, v24, v26
    v_lshrrev_b32 v27, 1, v26
    v_bfe_u32 v28, v25, 1, 2
    v_sub_u32 v27, v27, v28
    v_cmp_gt_i32 vcc, 0, v27
    v_add_u32 v28, 12, v27
    s_nop 0
    v_cndmask_b32 v27, v27, v28, vcc
    v_and_b32 v26, 1, v26
    v_lshlrev_b32 v26, 4, v26
    v_lshl_add_u32 v26, v27, 5, v26
    v_mul_u32_u24 v25, 3072, v25
    v_add_u32 v19, v25, v26
    v_subrev_u32 v19, 1024, v19
    v_add_u32 v24, 128, v0
    v_mul_u32_u24 v25, 2731, v24
    v_lshrrev_b32 v25, 16, v25
    v_mul_u32_u24 v26, 24, v25
    v_sub_u32 v26, v24, v26
    v_lshrrev_b32 v27, 1, v26
    v_bfe_u32 v28, v25, 1, 2
    v_sub_u32 v27, v27, v28
    v_cmp_gt_i32 vcc, 0, v27
    v_add_u32 v28, 12, v27
    s_nop 0
    v_cndmask_b32 v27, v27, v28, vcc
    v_and_b32 v26, 1, v26
    v_lshlrev_b32 v26, 4, v26
    v_lshl_add_u32 v26, v27, 5, v26
    v_mul_u32_u24 v25, 3072, v25
    v_add_u32 v20, v25, v26
    v_subrev_u32 v20, 2048, v20
    s_waitcnt vmcnt(13)
    s_barrier
    s_mul_i32 s11, s82, 245760
    s_add_u32 s12, s77, s13
    s_add_u32 m0, s12, 0
    s_add_u32 s11, s11, s80
    buffer_load_dwordx4 v6, s[44:47], s11 offen lds
    buffer_load_dwordx4 v7, s[44:47], s11 offen offset:1024 lds
    buffer_load_dwordx4 v8, s[44:47], s11 offen offset:2048 lds
    buffer_load_dwordx4 v9, s[44:47], s11 offen offset:3072 lds
    s_add_u32 m0, m0, 4096
    s_nop 0
    buffer_load_dwordx4 v10, s[44:47], s11 offen lds
    s_add_u32 s82, s82, 1
    s_cmp_eq_u32 s82, 10
    s_cselect_b32 s82, 0, s82
    s_add_u32 s77, s77, 20480
    s_cmp_eq_u32 s77, 61440
    s_cselect_b32 s77, 0, s77
    s_lshl_b32 s11, s76, 7
    s_add_u32 s11, s11, s79
    s_lshl_b32 s12, s76, 13
    s_add_u32 s12, s12, s14
    s_add_u32 m0, s12, 0
    s_add_u32 s12, s11, 9216
    buffer_load_dwordx4 v4, s[40:43], s11 offen lds
    buffer_load_dwordx4 v4, s[40:43], s12 offen offset:1024 lds
    s_add_u32 s76, s76, 1
    s_cmp_eq_u32 s76, 10
    s_cselect_b32 s76, 0, s76
    s_lshl_b32 s11, s76, 7
    s_add_u32 s11, s11, s79
    s_lshl_b32 s12, s76, 13
    s_add_u32 s12, s12, s14
    s_add_u32 m0, s12, 0
    s_add_u32 s12, s11, 9216
    buffer_load_dwordx4 v4, s[40:43], s11 offen lds
    buffer_load_dwordx4 v4, s[40:43], s12 offen offset:1024 lds
    s_add_u32 s76, s76, 1
    s_cmp_eq_u32 s76, 10
    s_cselect_b32 s76, 0, s76
    s_mov_b32 s60, s36
    s_mov_b32 s61, s37
    s_mov_b32 s62, 20971520
    s_mov_b32 s63, 0x00020000
    s_mov_b32 s48, s20
    s_mov_b32 s49, s21
    s_mov_b32 s50, 819200
    s_mov_b32 s51, 0x00020000
    s_mov_b32 s52, s24
    s_mov_b32 s53, s25
    s_mov_b32 s54, 1966080
    s_mov_b32 s55, 0x00020000
    s_mov_b32 s56, s28
    s_mov_b32 s57, s29
    s_mov_b32 s58, 1966080
    s_mov_b32 s59, 0x00020000
    s_waitcnt lgkmcnt(0)
    s_mul_i32 s7, s7, 0x9E3779B1
    s_add_u32 s7, s7, 0x7F4A7C15
    s_waitcnt vmcnt(13)
    s_barrier
    s_mul_i32 s11, s82, 245760
    s_add_u32 s12, s77, s13
    s_add_u32 m0, s12, 0
    s_add_u32 s11, s11, s80
    buffer_load_dwordx4 v6, s[44:47], s11 offen lds
    buffer_load_dwordx4 v7, s[44:47], s11 offen offset:1024 lds
    buffer_load_dwordx4 v8, s[44:47], s11 offen offset:2048 lds
    buffer_load_dwordx4 v9, s[44:47], s11 offen offset:3072 lds
    s_add_u32 m0, m0, 4096
    s_nop 0
    buffer_load_dwordx4 v10, s[44:47], s11 offen lds
    s_add_u32 s82, s82, 1
    s_cmp_eq_u32 s82, 10
    s_cselect_b32 s82, 0, s82
    s_add_u32 s77, s77, 20480
    s_cmp_eq_u32 s77, 61440
    s_cselect_b32 s77, 0, s77
    s_lshl_b32 s11, s76, 7
    s_add_u32 s11, s11, s79
    s_lshl_b32 s12, s76, 13
    s_add_u32 s12, s12, s14
    s_add_u32 m0, s12, 0
    s_add_u32 s12, s11, 9216
    buffer_load_dwordx4 v4, s[40:43], s11 offen lds
    buffer_load_dwordx4 v4, s[40:43], s12 offen offset:1024 lds
    s_add_u32 s76, s76, 1
    s_cmp_eq_u32 s76, 10
    s_cselect_b32 s76, 0, s76
    s_waitcnt vmcnt(11)
    s_barrier
    s_mul_i32 s11, s82, 245760
    s_add_u32 s12, s77, s13
    s_add_u32 m0, s12, 0
    s_add_u32 s11, s11, s80
    buffer_load_dwordx4 v6, s[44:47], s11 offen lds
    buffer_load_dwordx4 v7, s[44:47], s11 offen offset:1024 lds
    buffer_load_dwordx4 v8, s[44:47], s11 offen offset:2048 lds
    buffer_load_dwordx4 v9, s[44:47], s11 offen offset:3072 lds
    s_add_u32 m0, m0, 4096
    s_nop 0
    buffer_load_dwordx4 v10, s[44:47], s11 offen lds
    s_add_u32 s82, s82, 1
    s_cmp_eq_u32 s82, 10
    s_cselect_b32 s82, 0, s82
    s_add_u32 s77, s77, 20480
    s_cmp_eq_u32 s77, 61440
    s_cselect_b32 s77, 0, s77
    s_waitcnt vmcnt(7)
    s_barrier
    s_mul_i32 s11, s82, 245760
    s_add_u32 s12, s77, s13
    s_add_u32 m0, s12, 0
    s_add_u32 s11, s11, s80
    buffer_load_dwordx4 v6, s[44:47], s11 offen lds
    buffer_load_dwordx4 v7, s[44:47], s11 offen offset:1024 lds
    buffer_load_dwordx4 v8, s[44:47], s11 offen offset:2048 lds
    buffer_load_dwordx4 v9, s[44:47], s11 offen offset:3072 lds
    s_add_u32 m0, m0, 4096
    s_nop 0
    buffer_load_dwordx4 v10, s[44:47], s11 offen lds
    s_add_u32 s82, s82, 1
    s_cmp_eq_u32 s82, 10
    s_cselect_b32 s82, 0, s82
    s_add_u32 s77, s77, 20480
    s_cmp_eq_u32 s77, 61440
    s_cselect_b32 s77, 0, s77
    s_waitcnt vmcnt(5)
    s_barrier
    s_mul_i32 s11, s82, 245760
    s_add_u32 s12, s77, s13
    s_add_u32 m0, s12, 0
    s_add_u32 s11, s11, s80
    buffer_load_dwordx4 v6, s[44:47], s11 offen lds
    buffer_load_dwordx4 v7, s[44:47], s11 offen offset:1024 lds
    buffer_load_dwordx4 v8, s[44:47], s11 offen offset:2048 lds
    buffer_load_dwordx4 v9, s[44:47], s11 offen offset:3072 lds
    s_add_u32 m0, m0, 4096
    s_nop 0
    buffer_load_dwordx4 v10, s[44:47], s11 offen lds
    s_add_u32 s82, s82, 1
    s_cmp_eq_u32 s82, 10
    s_cselect_b32 s82, 0, s82
    s_add_u32 s77, s77, 20480
    s_cmp_eq_u32 s77, 61440
    s_cselect_b32 s77, 0, s77
    s_waitcnt vmcnt(5)
    s_barrier
    s_mul_i32 s11, s82, 245760
    s_add_u32 s12, s77, s13
    s_add_u32 m0, s12, 0
    s_add_u32 s11, s11, s80
    buffer_load_dwordx4 v6, s[44:47], s11 offen lds
    buffer_load_dwordx4 v7, s[44:47], s11 offen offset:1024 lds
    buffer_load_dwordx4 v8, s[44:47], s11 offen offset:2048 lds
    buffer_load_dwordx4 v9, s[44:47], s11 offen offset:3072 lds
    s_add_u32 m0, m0, 4096
    s_nop 0
    buffer_load_dwordx4 v10, s[44:47], s11 offen lds
    s_add_u32 s82, s82, 1
    s_cmp_eq_u32 s82, 10
    s_cselect_b32 s82, 0, s82
    s_add_u32 s77, s77, 20480
    s_cmp_eq_u32 s77, 61440
    s_cselect_b32 s77, 0, s77
    s_cmp_ge_u32 s9, 2
    s_cbranch_scc1 L_t167_37
    s_cmp_eq_u32 s9, 1
    s_cbranch_scc1 L_t15_36
    s_mul_i32 s11, s2, 3200
    s_mov_b64 exec, 0x1ffffff
    buffer_load_dword v33, v34, s[48:51], s11 offen
    s_mov_b64 exec, -1
    s_mul_i32 s11, s2, 7680
    s_mov_b32 exec_hi, 0x0fffffff
    buffer_load_dword v32, v34, s[52:55], s11 offen
    s_mov_b64 exec, -1
    s_branch L_t1e_38
L_t15_36:
    s_mul_i32 s11, s2, 7680
    s_mov_b32 exec_hi, 0x0fffffff
    buffer_load_dword v32, v34, s[56:59], s11 offen
    s_mov_b64 exec, -1
    v_lshlrev_b32 v24, 20, v0
    s_mov_b64 exec, 0xfffff
    buffer_load_dword v33, v24, s[60:63], 0 offen sc1
    s_mov_b64 exec, -1
    s_branch L_t1e_38
L_t167_37:
    s_sub_u32 s11, s9, 2
    s_mul_i32 s11, s11, 100
    s_lshr_b32 s12, s2, 3
    s_mul_i32 s12, s12, 76800
    v_add_u32 v24, s11, v0
    v_mul_u32_u24 v25, 6554, v24
    v_lshrrev_b32 v25, 16, v25
    v_mul_u32_u24 v26, 10, v25
    v_sub_u32 v26, v24, v26
    v_mul_u32_u24 v25, 3840, v25
    v_lshl_add_u32 v25, v26, 7, v25
    buffer_load_dword v32, v25, s[44:47], s12 offen
    v_add_u32 v24, s11, v0
    v_add_u32 v24, 64, v24
    v_mul_u32_u24 v25, 6554, v24
    v_lshrrev_b32 v25, 16, v25
    v_mul_u32_u24 v26, 10, v25
    v_sub_u32 v26, v24, v26
    v_mul_u32_u24 v25, 3840, v25
    v_lshl_add_u32 v25, v26, 7, v25
    s_mov_b32 exec_hi, 0xf
    buffer_load_dword v33, v25, s[44:47], s12 offen
    s_mov_b64 exec, -1
L_t1e_38:
    s_waitcnt vmcnt(7)
    s_barrier
    s_waitcnt vmcnt(2)
    s_barrier
    s_barrier
    s_cmp_ge_u32 s9, 2
    s_cbranch_scc1 L_noq_39
    s_mul_i32 s80, s6, 160
    s_mul_i32 s11, s9, 122880
    s_add_u32 s80, s80, s11
    s_mov_b32 s82, s39
    s_mul_i32 s13, s9, 5120
    s_add_u32 s13, s13, 81920
    s_mul_i32 s11, s82, 245760
    s_add_u32 m0, s13, 0
    s_add_u32 s11, s11, s80
    buffer_load_dwordx4 v6, s[44:47], s11 offen lds
    buffer_load_dwordx4 v7, s[44:47], s11 offen offset:1024 lds
    buffer_load_dwordx4 v8, s[44:47], s11 offen offset:2048 lds
    buffer_load_dwordx4 v9, s[44:47], s11 offen offset:3072 lds
    s_add_u32 m0, m0, 4096
    s_nop 0
    buffer_load_dwordx4 v10, s[44:47], s11 offen lds
    s_add_u32 s82, s82, 1
    s_cmp_eq_u32 s82, 10
    s_cselect_b32 s82, 0, s82
    s_mul_i32 s11, s82, 245760
    s_add_u32 m0, s13, 10240
    s_add_u32 s11, s11, s80
    buffer_load_dwordx4 v6, s[44:47], s11 offen lds
    buffer_load_dwordx4 v7, s[44:47], s11 offen offset:1024 lds
    buffer_load_dwordx4 v8, s[44:47], s11 offen offset:2048 lds
    buffer_load_dwordx4 v9, s[44:47], s11 offen offset:3072 lds
    s_add_u32 m0, m0, 4096
    s_nop 0
    buffer_load_dwordx4 v10, s[44:47], s11 offen lds
    s_add_u32 s82, s82, 1
    s_cmp_eq_u32 s82, 10
    s_cselect_b32 s82, 0, s82
    s_mul_i32 s11, s82, 245760
    s_add_u32 m0, s13, 20480
    s_add_u32 s11, s11, s80
    buffer_load_dwordx4 v6, s[44:47], s11 offen lds
    buffer_load_dwordx4 v7, s[44:47], s11 offen offset:1024 lds
    buffer_load_dwordx4 v8, s[44:47], s11 offen offset:2048 lds
    buffer_load_dwordx4 v9, s[44:47], s11 offen offset:3072 lds
    s_add_u32 m0, m0, 4096
    s_nop 0
    buffer_load_dwordx4 v10, s[44:47], s11 offen lds
    s_add_u32 s82, s82, 1
    s_cmp_eq_u32 s82, 10
    s_cselect_b32 s82, 0, s82
    s_mul_i32 s11, s82, 245760
    s_add_u32 m0, s13, 30720
    s_add_u32 s11, s11, s80
    buffer_load_dwordx4 v6, s[44:47], s11 offen lds
    buffer_load_dwordx4 v7, s[44:47], s11 offen offset:1024 lds
    buffer_load_dwordx4 v8, s[44:47], s11 offen offset:2048 lds
    buffer_load_dwordx4 v9, s[44:47], s11 offen offset:3072 lds
    s_add_u32 m0, m0, 4096
    s_nop 0
    buffer_load_dwordx4 v10, s[44:47], s11 offen lds
    s_add_u32 s82, s82, 1
    s_cmp_eq_u32 s82, 10
    s_cselect_b32 s82, 0, s82
    s_mul_i32 s11, s82, 245760
    s_add_u32 m0, s13, 40960
    s_add_u32 s11, s11, s80
    buffer_load_dwordx4 v6, s[44:47], s11 offen lds
    buffer_load_dwordx4 v7, s[44:47], s11 offen offset:1024 lds
    buffer_load_dwordx4 v8, s[44:47], s11 offen offset:2048 lds
    buffer_load_dwordx4 v9, s[44:47], s11 offen offset:3072 lds
    s_add_u32 m0, m0, 4096
    s_nop 0
    buffer_load_dwordx4 v10, s[44:47], s11 offen lds
    s_add_u32 s82, s82, 1
    s_cmp_eq_u32 s82, 10
    s_cselect_b32 s82, 0, s82
    s_mul_i32 s11, s82, 245760
    s_add_u32 m0, s13, 51200
    s_add_u32 s11, s11, s80
    buffer_load_dwordx4 v6, s[44:47], s11 offen lds
    buffer_load_dwordx4 v7, s[44:47], s11 offen offset:1024 lds
    buffer_load_dwordx4 v8, s[44:47], s11 offen offset:2048 lds
    buffer_load_dwordx4 v9, s[44:47], s11 offen offset:3072 lds
    s_add_u32 m0, m0, 4096
    s_nop 0
    buffer_load_dwordx4 v10, s[44:47], s11 offen lds
    s_add_u32 s82, s82, 1
    s_cmp_eq_u32 s82, 10
    s_cselect_b32 s82, 0, s82
    s_mul_i32 s11, s82, 245760
    s_add_u32 m0, s13, 61440
    s_add_u32 s11, s11, s80
    buffer_load_dwordx4 v6, s[44:47], s11 offen lds
    buffer_load_dwordx4 v7, s[44:47], s11 offen offset:1024 lds
    buffer_load_dwordx4 v8, s[44:47], s11 offen offset:2048 lds
    buffer_load_dwordx4 v9, s[44:47], s11 offen offset:3072 lds
    s_add_u32 m0, m0, 4096
    s_nop 0
    buffer_load_dwordx4 v10, s[44:47], s11 offen lds
    s_add_u32 s82, s82, 1
    s_cmp_eq_u32 s82, 10
    s_cselect_b32 s82, 0, s82
    s_waitcnt vmcnt(20)
    s_barrier
    s_waitcnt vmcnt(0)
    s_barrier
    s_mul_i32 s11, s82, 245760
    s_add_u32 m0, s13, 0
    s_add_u32 s11, s11, s80
    buffer_load_dwordx4 v6, s[44:47], s11 offen lds
    buffer_load_dwordx4 v7, s[44:47], s11 offen offset:1024 lds
    buffer_load_dwordx4 v8, s[44:47], s11 offen offset:2048 lds
    buffer_load_dwordx4 v9, s[44:47], s11 offen offset:3072 lds
    s_add_u32 m0, m0, 4096
    s_nop 0
    buffer_load_dwordx4 v10, s[44:47], s11 offen lds
    s_add_u32 s82, s82, 1
    s_cmp_eq_u32 s82, 10
    s_cselect_b32 s82, 0, s82
    s_mul_i32 s11, s82, 245760
    s_add_u32 m0, s13, 10240
    s_add_u32 s11, s11, s80
    buffer_load_dwordx4 v6, s[44:47], s11 offen lds
    buffer_load_dwordx4 v7, s[44:47], s11 offen offset:1024 lds
    buffer_load_dwordx4 v8, s[44:47], s11 offen offset:2048 lds
    buffer_load_dwordx4 v9, s[44:47], s11 offen offset:3072 lds
    s_add_u32 m0, m0, 4096
    s_nop 0
    buffer_load_dwordx4 v10, s[44:47], s11 offen lds
    s_add_u32 s82, s82, 1
    s_cmp_eq_u32 s82, 10
    s_cselect_b32 s82, 0, s82
    s_mul_i32 s11, s82, 245760
    s_add_u32 m0, s13, 20480
    s_add_u32 s11, s11, s80
    buffer_load_dwordx4 v6, s[44:47], s11 offen lds
    buffer_load_dwordx4 v7, s[44:47], s11 offen offset:1024 lds
    buffer_load_dwordx4 v8, s[44:47], s11 offen offset:2048 lds
    buffer_load_dwordx4 v9, s[44:47], s11 offen offset:3072 lds
    s_add_u32 m0, m0, 4096
    s_nop 0
    buffer_load_dwordx4 v10, s[44:47], s11 offen lds
    s_add_u32 s82, s82, 1
    s_cmp_eq_u32 s82, 10
    s_cselect_b32 s82, 0, s82
    s_waitcnt vmcnt(0)
    s_barrier
    s_lshr_b32 s11, s2, 3
    s_mul_i32 s11, s11, 25600
    s_mul_i32 s12, s9, 12800
    s_add_u32 s11, s11, s12
    buffer_load_dword v32, v34, s[48:51], s11 offen
    s_add_u32 s11, s11, 8192
    s_mov_b32 exec_hi, 0xf
    buffer_load_dword v32, v34, s[48:51], s11 offen
    s_mov_b64 exec, -1
    s_branch L_q3_41
L_noq_39:
    s_barrier
    s_barrier
    s_cmp_eq_u32 s9, 2
    s_cbranch_scc1 L_r6_43
    s_lshr_b32 s79, s2, 3
    s_and_b32 s80, s2, 7
    s_branch L_rgo_44
L_r6_43:
    s_cmp_ge_u32 s2, 64
    s_cbranch_scc1 L_nj_42
    s_lshr_b32 s79, s2, 1
    s_and_b32 s80, s2, 1
    s_add_u32 s80, s80, 8
L_rgo_44:
    v_lshrrev_b32 v28, 4, v0
    v_and_b32 v29, 15, v0
    v_mul_u32_u24 v27, 2560, v28
    v_lshl_add_u32 v27, v29, 4, v27
    s_mul_i32 s82, s79, 81920
    s_lshl_b32 s10, s80, 8
    s_add_u32 s82, s82, s10
    s_add_u32 s82, s82, 65536
    s_mov_b32 s78, 0
L_sp_45:
    s_mov_b32 s10, s82
    buffer_load_dwordx4 v[40:43], v27, s[60:63], s10 offen sc1
    s_add_u32 s10, s10, 10240
    buffer_load_dwordx4 v[44:47], v27, s[60:63], s10 offen sc1
    s_add_u32 s10, s10, 10240
    buffer_load_dwordx4 v[48:51], v27, s[60:63], s10 offen sc1
    s_add_u32 s10, s10, 10240
    buffer_load_dwordx4 v[52:55], v27, s[60:63], s10 offen sc1
    s_add_u32 s10, s10, 10240
    buffer_load_dwordx4 v[56:59], v27, s[60:63], s10 offen sc1
    s_add_u32 s10, s10, 10240
    buffer_load_dwordx4 v[60:63], v27, s[60:63], s10 offen sc1
    s_add_u32 s10, s10, 10240
    buffer_load_dwordx4 v[64:67], v27, s[60:63], s10 offen sc1
    s_add_u32 s10, s10, 10240
    buffer_load_dwordx4 v[68:71], v27, s[60:63], s10 offen sc1
    s_waitcnt vmcnt(0)
    s_lshl_b32 s98, s7, 16
    s_mov_b32 s99, 0xffff0000
    v_mov_b32 v24, 0
    v_xor_b32 v25, s98, v41
    v_xor_b32 v26, s98, v43
    v_or3_b32 v24, v24, v25, v26
    v_xor_b32 v25, s98, v45
    v_xor_b32 v26, s98, v47
    v_or3_b32 v24, v24, v25, v26
    v_xor_b32 v25, s98, v49
    v_xor_b32 v26, s98, v51
    v_or3_b32 v24, v24, v25, v26
    v_xor_b32 v25, s98, v53
    v_xor_b32 v26, s98, v55
    v_or3_b32 v24, v24, v25, v26
    v_xor_b32 v25, s98, v57
    v_xor_b32 v26, s98, v59
    v_or3_b32 v24, v24, v25, v26
    v_xor_b32 v25, s98, v61
    v_xor_b32 v26, s98, v63
    v_or3_b32 v24, v24, v25, v26
    v_xor_b32 v25, s98, v65
    v_xor_b32 v26, s98, v67
    v_or3_b32 v24, v24, v25, v26
    v_xor_b32 v25, s98, v69
    v_xor_b32 v26, s98, v71
    v_or3_b32 v24, v24, v25, v26
    v_and_b32 v24, s99, v24
    v_cmp_ne_u32 vcc, 0, v24
    s_add_u32 s78, s78, 1
    s_cmp_gt_u32 s78, 200000
    s_cbranch_scc1 L_spd_46
    s_nop 1
    s_cbranch_vccz L_spd_46
    s_branch L_sp_45
L_spd_46:
    s_mov_b32 s96, 0x0201000c
    s_mov_b32 s97, 0x0504030c
    v_perm_b32 v72, v40, v40, s96
    v_perm_b32 v73, v41, v40, s97
    v_perm_b32 v74, v42, v42, s96
    v_perm_b32 v75, v43, v42, s97
    v_perm_b32 v76, v44, v44, s96
    v_perm_b32 v77, v45, v44, s97
    v_perm_b32 v78, v46, v46, s96
    v_perm_b32 v79, v47, v46, s97
    v_pk_add_f32 v[72:73], v[72:73], v[76:77]
    v_pk_add_f32 v[74:75], v[74:75], v[78:79]
    v_perm_b32 v76, v48, v48, s96
    v_perm_b32 v77, v49, v48, s97
    v_perm_b32 v78, v50, v50, s96
    v_perm_b32 v79, v51, v50, s97
    v_pk_add_f32 v[72:73], v[72:73], v[76:77]
    v_pk_add_f32 v[74:75], v[74:75], v[78:79]
    v_perm_b32 v76, v52, v52, s96
    v_perm_b32 v77, v53, v52, s97
    v_perm_b32 v78, v54, v54, s96
    v_perm_b32 v79, v55, v54, s97
    v_pk_add_f32 v[72:73], v[72:73], v[76:77]
    v_pk_add_f32 v[74:75], v[74:75], v[78:79]
    v_perm_b32 v76, v56, v56, s96
    v_perm_b32 v77, v57, v56, s97
    v_perm_b32 v78, v58, v58, s96
    v_perm_b32 v79, v59, v58, s97
    v_pk_add_f32 v[72:73], v[72:73], v[76:77]
    v_pk_add_f32 v[74:75], v[74:75], v[78:79]
    v_perm_b32 v76, v60, v60, s96
    v_perm_b32 v77, v61, v60, s97
    v_perm_b32 v78, v62, v62, s96
    v_perm_b32 v79, v63, v62, s97
    v_pk_add_f32 v[72:73], v[72:73], v[76:77]
    v_pk_add_f32 v[74:75], v[74:75], v[78:79]
    v_perm_b32 v76, v64, v64, s96
    v_perm_b32 v77, v65, v64, s97
    v_perm_b32 v78, v66, v66, s96
    v_perm_b32 v79, v67, v66, s97
    v_pk_add_f32 v[72:73], v[72:73], v[76:77]
    v_pk_add_f32 v[74:75], v[74:75], v[78:79]
    v_perm_b32 v76, v68, v68, s96
    v_perm_b32 v77, v69, v68, s97
    v_perm_b32 v78, v70, v70, s96
    v_perm_b32 v79, v71, v70, s97
    v_pk_add_f32 v[72:73], v[72:73], v[76:77]
    v_pk_add_f32 v[74:75], v[74:75], v[78:79]
    s_lshl_b32 s10, s9, 10
    s_add_u32 s10, s10, 154624
    v_add_u32 v26, s10, v2
    ds_write_b128 v26, v[72:75]
    v_lshlrev_b32 v25, 4, v29
    v_add_u32 v26, s10, v25
    s_waitcnt lgkmcnt(0)
    ds_read_b128 v[40:43], v26 offset:0
    ds_read_b128 v[44:47], v26 offset:256
    ds_read_b128 v[48:51], v26 offset:512
    ds_read_b128 v[52:55], v26 offset:768
    s_mov_b32 s96, 0x05030201
    s_mov_b32 s97, 0x05040302
    v_mov_b32 v24, s7
    s_mul_i32 s10, s79, 2560
    s_lshl_b32 s11, s80, 8
    s_add_u32 s10, s10, s11
    s_add_u32 s10, s10, 2686976
    s_waitcnt lgkmcnt(0)
    v_pk_add_f32 v[40:41], v[40:41], v[44:45]
    v_pk_add_f32 v[42:43], v[42:43], v[46:47]
    v_pk_add_f32 v[48:49], v[48:49], v[52:53]
    v_pk_add_f32 v[50:51], v[50:51], v[54:55]
    v_pk_add_f32 v[40:41], v[40:41], v[48:49]
    v_pk_add_f32 v[42:43], v[42:43], v[50:51]
    v_perm_b32 v56, v41, v40, s96
    v_perm_b32 v57, v24, v41, s97
    v_perm_b32 v58, v43, v42, s96
    v_perm_b32 v59, v24, v43, s97
    s_mov_b64 exec, 0xffff
    buffer_store_dwordx4 v[56:59], v25, s[60:63], s10 offen sc1
    s_mov_b64 exec, -1
L_nj_42:
    s_barrier
L_q3_41:
    s_barrier
    s_cmp_ge_u32 s9, 2
    s_cbranch_scc1 L_wo_47
    s_mov_b32 s81, 0
    s_cmp_lg_u32 s9, 1
    s_cbranch_scc1 L_rs_48
    s_cmp_ge_u32 s5, 16
    s_cbranch_scc1 L_rs_48
    s_mul_i32 s14, s5, 122880
    s_mul_i32 s11, s6, 160
    s_add_u32 s14, s14, s11
    s_mov_b32 s15, 118784
    s_mov_b32 s81, 1
    s_add_u32 m0, s15, 0
    s_nop 0
    buffer_load_dwordx4 v12, s[56:59], s14 offen lds
    buffer_load_dwordx4 v13, s[56:59], s14 offen offset:1024 lds
    buffer_load_dwordx4 v14, s[56:59], s14 offen offset:2048 lds
    buffer_load_dwordx4 v15, s[56:59], s14 offen offset:3072 lds
    s_add_u32 m0, m0, 4096
    s_nop 0
    buffer_load_dwordx4 v16, s[56:59], s14 offen lds
    s_add_u32 m0, s15, 5120
    s_add_u32 s14, s14, 40960
    buffer_load_dwordx4 v12, s[56:59], s14 offen lds
    buffer_load_dwordx4 v13, s[56:59], s14 offen offset:1024 lds
    buffer_load_dwordx4 v14, s[56:59], s14 offen offset:2048 lds
    buffer_load_dwordx4 v15, s[56:59], s14 offen offset:3072 lds
    s_add_u32 m0, m0, 4096
    s_nop 0
    buffer_load_dwordx4 v16, s[56:59], s14 offen lds
    s_add_u32 m0, s15, 10240
    s_add_u32 s14, s14, 40960
    buffer_load_dwordx4 v12, s[56:59], s14 offen lds
    buffer_load_dwordx4 v13, s[56:59], s14 offen offset:1024 lds
    buffer_load_dwordx4 v14, s[56:59], s14 offen offset:2048 lds
    buffer_load_dwordx4 v15, s[56:59], s14 offen offset:3072 lds
    s_add_u32 m0, m0, 4096
    s_nop 0
    buffer_load_dwordx4 v16, s[56:59], s14 offen lds
L_rs_48:
    s_mul_i32 s11, s6, 160
    s_mul_i32 s12, s9, 409600
    s_add_u32 s79, s11, s12
    s_mul_i32 s80, s9, 51200
    s_add_u32 s80, s80, 0
    s_mul_i32 s13, s38, 3
    s_mul_i32 s14, s13, 40960
    s_mul_i32 s15, s13, 5120
    s_add_u32 s15, s15, s80
    s_add_u32 m0, s15, 0
    s_add_u32 s14, s14, s79
    buffer_load_dwordx4 v12, s[48:51], s14 offen lds
    s_waitcnt vmcnt(12)
    buffer_load_dwordx4 v13, s[48:51], s14 offen offset:1024 lds
    s_waitcnt vmcnt(12)
    buffer_load_dwordx4 v14, s[48:51], s14 offen offset:2048 lds
    s_waitcnt vmcnt(12)
    buffer_load_dwordx4 v15, s[48:51], s14 offen offset:3072 lds
    s_waitcnt vmcnt(12)
    s_add_u32 m0, m0, 4096
    s_nop 0
    buffer_load_dwordx4 v16, s[48:51], s14 offen lds
    s_waitcnt vmcnt(12)
    s_add_u32 s13, s13, 1
    s_cmp_eq_u32 s13, 10
    s_cselect_b32 s13, 0, s13
    s_mul_i32 s14, s13, 40960
    s_mul_i32 s15, s13, 5120
    s_add_u32 s15, s15, s80
    s_add_u32 m0, s15, 0
    s_add_u32 s14, s14, s79
    buffer_load_dwordx4 v12, s[48:51], s14 offen lds
    s_waitcnt vmcnt(12)
    buffer_load_dwordx4 v13, s[48:51], s14 offen offset:1024 lds
    s_waitcnt vmcnt(12)
    buffer_load_dwordx4 v14, s[48:51], s14 offen offset:2048 lds
    s_waitcnt vmcnt(12)
    buffer_load_dwordx4 v15, s[48:51], s14 offen offset:3072 lds
    s_waitcnt vmcnt(12)
    s_add_u32 m0, m0, 4096
    s_nop 0
    buffer_load_dwordx4 v16, s[48:51], s14 offen lds
    s_waitcnt vmcnt(12)
    s_add_u32 s13, s13, 1
    s_cmp_eq_u32 s13, 10
    s_cselect_b32 s13, 0, s13
    s_mul_i32 s14, s13, 40960
    s_mul_i32 s15, s13, 5120
    s_add_u32 s15, s15, s80
    s_add_u32 m0, s15, 0
    s_add_u32 s14, s14, s79
    buffer_load_dwordx4 v12, s[48:51], s14 offen lds
    s_waitcnt vmcnt(12)
    buffer_load_dwordx4 v13, s[48:51], s14 offen offset:1024 lds
    s_waitcnt vmcnt(12)
    buffer_load_dwordx4 v14, s[48:51], s14 offen offset:2048 lds
    s_waitcnt vmcnt(12)
    buffer_load_dwordx4 v15, s[48:51], s14 offen offset:3072 lds
    s_waitcnt vmcnt(12)
    s_add_u32 m0, m0, 4096
    s_nop 0
    buffer_load_dwordx4 v16, s[48:51], s14 offen lds
    s_waitcnt vmcnt(12)
    s_add_u32 s13, s13, 1
    s_cmp_eq_u32 s13, 10
    s_cselect_b32 s13, 0, s13
    s_mul_i32 s14, s13, 40960
    s_mul_i32 s15, s13, 5120
    s_add_u32 s15, s15, s80
    s_add_u32 m0, s15, 0
    s_add_u32 s14, s14, s79
    buffer_load_dwordx4 v12, s[48:51], s14 offen lds
    s_waitcnt vmcnt(12)
    buffer_load_dwordx4 v13, s[48:51], s14 offen offset:1024 lds
    s_waitcnt vmcnt(12)
    buffer_load_dwordx4 v14, s[48:51], s14 offen offset:2048 lds
    s_waitcnt vmcnt(12)
    buffer_load_dwordx4 v15, s[48:51], s14 offen offset:3072 lds
    s_waitcnt vmcnt(12)
    s_add_u32 m0, m0, 4096
    s_nop 0
    buffer_load_dwordx4 v16, s[48:51], s14 offen lds
    s_waitcnt vmcnt(12)
    s_add_u32 s13, s13, 1
    s_cmp_eq_u32 s13, 10
    s_cselect_b32 s13, 0, s13
    s_mul_i32 s14, s13, 40960
    s_mul_i32 s15, s13, 5120
    s_add_u32 s15, s15, s80
    s_add_u32 m0, s15, 0
    s_add_u32 s14, s14, s79
    buffer_load_dwordx4 v12, s[48:51], s14 offen lds
    s_waitcnt vmcnt(12)
    buffer_load_dwordx4 v13, s[48:51], s14 offen offset:1024 lds
    s_waitcnt vmcnt(12)
    buffer_load_dwordx4 v14, s[48:51], s14 offen offset:2048 lds
    s_waitcnt vmcnt(12)
    buffer_load_dwordx4 v15, s[48:51], s14 offen offset:3072 lds
    s_waitcnt vmcnt(12)
    s_add_u32 m0, m0, 4096
    s_nop 0
    buffer_load_dwordx4 v16, s[48:51], s14 offen lds
    s_waitcnt vmcnt(12)
    s_add_u32 s13, s13, 1
    s_cmp_eq_u32 s13, 10
    s_cselect_b32 s13, 0, s13
    s_mul_i32 s14, s13, 40960
    s_mul_i32 s15, s13, 5120
    s_add_u32 s15, s15, s80
    s_add_u32 m0, s15, 0
    s_add_u32 s14, s14, s79
    buffer_load_dwordx4 v12, s[48:51], s14 offen lds
    s_waitcnt vmcnt(12)
    buffer_load_dwordx4 v13, s[48:51], s14 offen offset:1024 lds
    s_waitcnt vmcnt(12)
    buffer_load_dwordx4 v14, s[48:51], s14 offen offset:2048 lds
    s_waitcnt vmcnt(12)
    buffer_load_dwordx4 v15, s[48:51], s14 offen offset:3072 lds
    s_waitcnt vmcnt(12)
    s_add_u32 m0, m0, 4096
    s_nop 0
    buffer_load_dwordx4 v16, s[48:51], s14 offen lds
    s_waitcnt vmcnt(12)
    s_add_u32 s13, s13, 1
    s_cmp_eq_u32 s13, 10
    s_cselect_b32 s13, 0, s13
    s_mul_i32 s14, s13, 40960
    s_mul_i32 s15, s13, 5120
    s_add_u32 s15, s15, s80
    s_add_u32 m0, s15, 0
    s_add_u32 s14, s14, s79
    buffer_load_dwordx4 v12, s[48:51], s14 offen lds
    s_waitcnt vmcnt(12)
    buffer_load_dwordx4 v13, s[48:51], s14 offen offset:1024 lds
    s_waitcnt vmcnt(12)
    buffer_load_dwordx4 v14, s[48:51], s14 offen offset:2048 lds
    s_waitcnt vmcnt(12)
    buffer_load_dwordx4 v15, s[48:51], s14 offen offset:3072 lds
    s_waitcnt vmcnt(12)
    s_add_u32 m0, m0, 4096
    s_nop 0
    buffer_load_dwordx4 v16, s[48:51], s14 offen lds
    s_waitcnt vmcnt(12)
    s_add_u32 s13, s13, 1
    s_cmp_eq_u32 s13, 10
    s_cselect_b32 s13, 0, s13
    s_mul_i32 s14, s13, 40960
    s_mul_i32 s15, s13, 5120
    s_add_u32 s15, s15, s80
    s_add_u32 m0, s15, 0
    s_add_u32 s14, s14, s79
    buffer_load_dwordx4 v12, s[48:51], s14 offen lds
    s_waitcnt vmcnt(12)
    buffer_load_dwordx4 v13, s[48:51], s14 offen offset:1024 lds
    s_waitcnt vmcnt(12)
    buffer_load_dwordx4 v14, s[48:51], s14 offen offset:2048 lds
    s_waitcnt vmcnt(12)
    buffer_load_dwordx4 v15, s[48:51], s14 offen offset:3072 lds
    s_waitcnt vmcnt(12)
    s_add_u32 m0, m0, 4096
    s_nop 0
    buffer_load_dwordx4 v16, s[48:51], s14 offen lds
    s_waitcnt vmcnt(12)
    s_add_u32 s13, s13, 1
    s_cmp_eq_u32 s13, 10
    s_cselect_b32 s13, 0, s13
    s_mul_i32 s14, s13, 40960
    s_mul_i32 s15, s13, 5120
    s_add_u32 s15, s15, s80
    s_add_u32 m0, s15, 0
    s_add_u32 s14, s14, s79
    buffer_load_dwordx4 v12, s[48:51], s14 offen lds
    s_waitcnt vmcnt(12)
    buffer_load_dwordx4 v13, s[48:51], s14 offen offset:1024 lds
    s_waitcnt vmcnt(12)
    buffer_load_dwordx4 v14, s[48:51], s14 offen offset:2048 lds
    s_waitcnt vmcnt(12)
    buffer_load_dwordx4 v15, s[48:51], s14 offen offset:3072 lds
    s_waitcnt vmcnt(12)
    s_add_u32 m0, m0, 4096
    s_nop 0
    buffer_load_dwordx4 v16, s[48:51], s14 offen lds
    s_waitcnt vmcnt(12)
    s_add_u32 s13, s13, 1
    s_cmp_eq_u32 s13, 10
    s_cselect_b32 s13, 0, s13
    s_mul_i32 s14, s13, 40960
    s_mul_i32 s15, s13, 5120
    s_add_u32 s15, s15, s80
    s_add_u32 m0, s15, 0
    s_add_u32 s14, s14, s79
    buffer_load_dwordx4 v12, s[48:51], s14 offen lds
    s_waitcnt vmcnt(12)
    buffer_load_dwordx4 v13, s[48:51], s14 offen offset:1024 lds
    s_waitcnt vmcnt(12)
    buffer_load_dwordx4 v14, s[48:51], s14 offen offset:2048 lds
    s_waitcnt vmcnt(12)
    buffer_load_dwordx4 v15, s[48:51], s14 offen offset:3072 lds
    s_waitcnt vmcnt(12)
    s_add_u32 m0, m0, 4096
    s_nop 0
    buffer_load_dwordx4 v16, s[48:51], s14 offen lds
    s_waitcnt vmcnt(12)
    s_add_u32 s13, s13, 1
    s_cmp_eq_u32 s13, 10
    s_cselect_b32 s13, 0, s13
    s_branch L_w45_49
L_wo_47:
    s_barrier
    s_branch L_w5_50
L_w45_49:
    s_waitcnt vmcnt(0)
    s_cmp_lg_u32 s9, 1
    s_cbranch_scc1 L_frf_52
    s_cmp_eq_u32 s81, 0
    s_cbranch_scc1 L_rq_51
    v_and_b32 v24, 15, v0
    v_lshrrev_b32 v25, 4, v0
    v_lshrrev_b32 v24, 2, v24
    v_lshl_add_u32 v24, v25, 2, v24
    v_mul_u32_u24 v24, 160, v24
    v_and_b32 v25, 3, v0
    v_lshl_add_u32 v24, v25, 3, v24
    v_add_u32 v24, 118784, v24
    ds_read_b64_tr_b16 v[40:41], v24 offset:0
    ds_read_b64_tr_b16 v[42:43], v24 offset:2560
    ds_read_b64_tr_b16 v[44:45], v24 offset:32
    ds_read_b64_tr_b16 v[46:47], v24 offset:2592
    ds_read_b64_tr_b16 v[48:49], v24 offset:64
    ds_read_b64_tr_b16 v[50:51], v24 offset:2624
    ds_read_b64_tr_b16 v[52:53], v24 offset:96
    ds_read_b64_tr_b16 v[54:55], v24 offset:2656
    ds_read_b64_tr_b16 v[56:57], v24 offset:128
    ds_read_b64_tr_b16 v[58:59], v24 offset:2688
    s_waitcnt lgkmcnt(0)
    ds_read_b64_tr_b16 v[60:61], v24 offset:7680
    ds_read_b64_tr_b16 v[62:63], v24 offset:10240
    ds_read_b64_tr_b16 v[64:65], v24 offset:7712
    ds_read_b64_tr_b16 v[66:67], v24 offset:10272
    ds_read_b64_tr_b16 v[68:69], v24 offset:7744
    ds_read_b64_tr_b16 v[70:71], v24 offset:10304
    ds_read_b64_tr_b16 v[72:73], v24 offset:7776
    ds_read_b64_tr_b16 v[74:75], v24 offset:10336
    ds_read_b64_tr_b16 v[76:77], v24 offset:7808
    ds_read_b64_tr_b16 v[78:79], v24 offset:10368
    s_waitcnt lgkmcnt(0)
    ds_read_b64_tr_b16 v[80:81], v24 offset:5120
    ds_read_b64_tr_b16 v[82:83], v24 offset:12800
    ds_read_b64_tr_b16 v[84:85], v24 offset:5152
    ds_read_b64_tr_b16 v[86:87], v24 offset:12832
    ds_read_b64_tr_b16 v[88:89], v24 offset:5184
    ds_read_b64_tr_b16 v[90:91], v24 offset:12864
    ds_read_b64_tr_b16 v[92:93], v24 offset:5216
    ds_read_b64_tr_b16 v[94:95], v24 offset:12896
    ds_read_b64_tr_b16 v[96:97], v24 offset:5248
    ds_read_b64_tr_b16 v[98:99], v24 offset:12928
    s_waitcnt lgkmcnt(0)
    s_mul_i32 s80, s5, 15360
    s_mul_i32 s11, s6, 245760
    s_add_u32 s80, s80, s11
    s_add_u32 s80, s80, 17825792
    buffer_store_dwordx4 v[40:43], v2, s[60:63], s80 offen offset:0 sc1
    buffer_store_dwordx4 v[44:47], v2, s[60:63], s80 offen offset:1024 sc1
    buffer_store_dwordx4 v[48:51], v2, s[60:63], s80 offen offset:2048 sc1
    buffer_store_dwordx4 v[52:55], v2, s[60:63], s80 offen offset:3072 sc1
    s_add_u32 s80, s80, 4096
    buffer_store_dwordx4 v[56:59], v2, s[60:63], s80 offen offset:0 sc1
    buffer_store_dwordx4 v[60:63], v2, s[60:63], s80 offen offset:1024 sc1
    buffer_store_dwordx4 v[64:67], v2, s[60:63], s80 offen offset:2048 sc1
    buffer_store_dwordx4 v[68:71], v2, s[60:63], s80 offen offset:3072 sc1
    s_add_u32 s80, s80, 4096
    buffer_store_dwordx4 v[72:75], v2, s[60:63], s80 offen offset:0 sc1
    buffer_store_dwordx4 v[76:79], v2, s[60:63], s80 offen offset:1024 sc1
    buffer_store_dwordx4 v[80:83], v2, s[60:63], s80 offen offset:2048 sc1
    buffer_store_dwordx4 v[84:87], v2, s[60:63], s80 offen offset:3072 sc1
    s_add_u32 s80, s80, 4096
    buffer_store_dwordx4 v[88:91], v2, s[60:63], s80 offen offset:0 sc1
    buffer_store_dwordx4 v[92:95], v2, s[60:63], s80 offen offset:1024 sc1
    buffer_store_dwordx4 v[96:99], v2, s[60:63], s80 offen offset:2048 sc1
    s_barrier
    s_waitcnt vmcnt(0)
    s_lshl_b32 s10, s6, 7
    s_lshl_b32 s11, s5, 2
    s_add_u32 s10, s10, s11
    s_add_u32 s10, s10, 28672
    v_mov_b32 v24, s7
    s_mov_b64 exec, 1
    buffer_store_dword v24, v3, s[60:63], s10 offen sc1
    s_mov_b64 exec, -1
    s_branch L_w5_50
L_rq_51:
    s_lshl_b32 s10, s6, 7
    s_lshl_b32 s11, s5, 2
    s_add_u32 s10, s10, s11
    s_add_u32 s10, s10, 28672
    v_mov_b32 v24, s7
    s_mov_b64 exec, 1
    buffer_store_dword v24, v3, s[60:63], s10 offen sc1
    s_mov_b64 exec, -1
L_frf_52:
    s_barrier
L_w5_50:
    s_mul_i32 s79, s6, 384
    s_mul_i32 s80, s9, 3072
    s_add_u32 s80, s80, 81920
    s_mov_b32 s77, 24576
    s_lshl_b32 s11, s5, 2
    s_add_u32 s11, s11, s9
    s_mul_i32 s81, s11, 20480
    s_add_u32 s81, s81, 5767168
    s_lshl_b32 s82, s9, 10
    s_add_u32 s82, s82, 0
    s_lshl_b32 s76, s38, 1
    s_mov_b32 s83, s76
    s_mul_i32 s11, s76, 80
    s_lshl_b32 s12, s9, 3
    s_add_u32 s11, s11, s12
    s_mul_i32 s11, s11, 3072
    s_add_u32 s12, s77, s80
    s_add_u32 m0, s12, 0
    s_add_u32 s11, s11, s79
    buffer_load_dwordx4 v18, s[52:55], s11 offen lds
    s_waitcnt vmcnt(3)
    buffer_load_dwordx4 v19, s[52:55], s11 offen offset:1024 lds
    s_waitcnt vmcnt(3)
    buffer_load_dwordx4 v20, s[52:55], s11 offen offset:2048 lds
    s_waitcnt vmcnt(3)
    s_mul_i32 s11, s76, 80
    s_lshl_b32 s12, s9, 3
    s_add_u32 s11, s11, s12
    s_add_u32 s11, s11, 32
    s_mul_i32 s11, s11, 3072
    s_add_u32 s12, s77, s80
    s_add_u32 m0, s12, 12288
    s_add_u32 s11, s11, s79
    buffer_load_dwordx4 v18, s[52:55], s11 offen lds
    s_waitcnt vmcnt(3)
    buffer_load_dwordx4 v19, s[52:55], s11 offen offset:1024 lds
    s_waitcnt vmcnt(3)
    buffer_load_dwordx4 v20, s[52:55], s11 offen offset:2048 lds
    s_waitcnt vmcnt(3)
    s_add_u32 s77, s77, 24576
    s_cmp_eq_u32 s77, 73728
    s_cselect_b32 s77, 0, s77
    s_add_u32 s76, s76, 1
    s_and_b32 s76, s76, 7
    s_mul_i32 s11, s76, 80
    s_lshl_b32 s12, s9, 3
    s_add_u32 s11, s11, s12
    s_mul_i32 s11, s11, 3072
    s_add_u32 s12, s77, s80
    s_add_u32 m0, s12, 0
    s_add_u32 s11, s11, s79
    buffer_load_dwordx4 v18, s[52:55], s11 offen lds
    s_waitcnt vmcnt(3)
    buffer_load_dwordx4 v19, s[52:55], s11 offen offset:1024 lds
    s_waitcnt vmcnt(3)
    buffer_load_dwordx4 v20, s[52:55], s11 offen offset:2048 lds
    s_waitcnt vmcnt(3)
    s_mul_i32 s11, s76, 80
    s_lshl_b32 s12, s9, 3
    s_add_u32 s11, s11, s12
    s_add_u32 s11, s11, 32
    s_mul_i32 s11, s11, 3072
    s_add_u32 s12, s77, s80
    s_add_u32 m0, s12, 12288
    s_add_u32 s11, s11, s79
    buffer_load_dwordx4 v18, s[52:55], s11 offen lds
    s_waitcnt vmcnt(3)
    buffer_load_dwordx4 v19, s[52:55], s11 offen offset:1024 lds
    s_waitcnt vmcnt(3)
    buffer_load_dwordx4 v20, s[52:55], s11 offen offset:2048 lds
    s_waitcnt vmcnt(3)
    s_add_u32 s77, s77, 24576
    s_cmp_eq_u32 s77, 73728
    s_cselect_b32 s77, 0, s77
    s_add_u32 s76, s76, 1
    s_and_b32 s76, s76, 7
    s_cmp_lg_u32 s9, 3
    s_cbranch_scc1 L_fr_53
    s_lshl_b32 s10, s6, 7
    s_add_u32 s10, s10, 28672
    s_add_u32 s100, s36, s10
    s_addc_u32 s101, s37, 0
    s_mov_b32 s78, 0
L_frl_54:
    s_load_dwordx16 s[16:31], s[100:101], 0 glc
    s_waitcnt lgkmcnt(0)
    s_xor_b32 s10, s16, s7
    s_xor_b32 s11, s17, s7
    s_or_b32 s10, s10, s11
    s_xor_b32 s11, s18, s7
    s_or_b32 s10, s10, s11
    s_xor_b32 s11, s19, s7
    s_or_b32 s10, s10, s11
    s_xor_b32 s11, s20, s7
    s_or_b32 s10, s10, s11
    s_xor_b32 s11, s21, s7
    s_or_b32 s10, s10, s11
    s_xor_b32 s11, s22, s7
    s_or_b32 s10, s10, s11
    s_xor_b32 s11, s23, s7
    s_or_b32 s10, s10, s11
    s_xor_b32 s11, s24, s7
    s_or_b32 s10, s10, s11
    s_xor_b32 s11, s25, s7
    s_or_b32 s10, s10, s11
    s_xor_b32 s11, s26, s7
    s_or_b32 s10, s10, s11
    s_xor_b32 s11, s27, s7
    s_or_b32 s10, s10, s11
    s_xor_b32 s11, s28, s7
    s_or_b32 s10, s10, s11
    s_xor_b32 s11, s29, s7
    s_or_b32 s10, s10, s11
    s_xor_b32 s11, s30, s7
    s_or_b32 s10, s10, s11
    s_xor_b32 s11, s31, s7
    s_or_b32 s10, s10, s11
    s_load_dwordx16 s[16:31], s[100:101], 64 glc
    s_waitcnt lgkmcnt(0)
    s_xor_b32 s11, s16, s7
    s_or_b32 s10, s10, s11
    s_xor_b32 s11, s17, s7
    s_or_b32 s10, s10, s11
    s_xor_b32 s11, s18, s7
    s_or_b32 s10, s10, s11
    s_xor_b32 s11, s19, s7
    s_or_b32 s10, s10, s11
    s_xor_b32 s11, s20, s7
    s_or_b32 s10, s10, s11
    s_xor_b32 s11, s21, s7
    s_or_b32 s10, s10, s11
    s_xor_b32 s11, s22, s7
    s_or_b32 s10, s10, s11
    s_xor_b32 s11, s23, s7
    s_or_b32 s10, s10, s11
    s_xor_b32 s11, s24, s7
    s_or_b32 s10, s10, s11
    s_xor_b32 s11, s25, s7
    s_or_b32 s10, s10, s11
    s_xor_b32 s11, s26, s7
    s_or_b32 s10, s10, s11
    s_xor_b32 s11, s27, s7
    s_or_b32 s10, s10, s11
    s_xor_b32 s11, s28, s7
    s_or_b32 s10, s10, s11
    s_xor_b32 s11, s29, s7
    s_or_b32 s10, s10, s11
    s_xor_b32 s11, s30, s7
    s_or_b32 s10, s10, s11
    s_xor_b32 s11, s31, s7
    s_or_b32 s10, s10, s11
    s_cmp_eq_u32 s10, 0
    s_cbranch_scc1 L_frd_55
    s_add_u32 s78, s78, 1
    s_cmp_lt_u32 s78, 200000
    s_cbranch_scc1 L_frl_54
L_frd_55:
    v_mov_b32 v24, 156188
    v_mov_b32 v25, 1
    s_mov_b64 exec, 1
    ds_write_b32 v24, v25
    s_mov_b64 exec, -1
    s_waitcnt lgkmcnt(0)
L_fr_53:
    v_mov_b32 v24, 156180
    s_cmp_lg_u32 s9, 0
    s_cbranch_scc1 L_shf_56
    s_lshl_b32 s10, s5, 7
    s_add_u32 s10, s10, 16384
    s_add_u32 s100, s36, s10
    s_addc_u32 s101, s37, 0
    s_mov_b32 s78, 0
L_sq_60:
    s_load_dwordx8 s[64:71], s[100:101], 0 glc
    s_waitcnt lgkmcnt(0)
    s_xor_b32 s10, s64, s7
    s_xor_b32 s11, s65, s7
    s_or_b32 s10, s10, s11
    s_xor_b32 s11, s66, s7
    s_or_b32 s10, s10, s11
    s_xor_b32 s11, s67, s7
    s_or_b32 s10, s10, s11
    s_xor_b32 s11, s68, s7
    s_or_b32 s10, s10, s11
    s_xor_b32 s11, s69, s7
    s_or_b32 s10, s10, s11
    s_xor_b32 s11, s70, s7
    s_or_b32 s10, s10, s11
    s_xor_b32 s11, s71, s7
    s_or_b32 s10, s10, s11
    s_cmp_eq_u32 s10, 0
    s_cbranch_scc1 L_sqd_61
    s_add_u32 s78, s78, 1
    s_cmp_lt_u32 s78, 200000
    s_cbranch_scc1 L_sq_60
L_sqd_61:
    v_mov_b32 v25, 1
    s_mov_b64 exec, 1
    ds_write_b32 v24, v25
    s_mov_b64 exec, -1
    s_waitcnt lgkmcnt(0)
    s_branch L_she_57
L_shf_56:
    s_mov_b32 s78, 0
L_shl_58:
    ds_read_b32 v25, v24
    s_waitcnt lgkmcnt(0)
    v_readfirstlane_b32 s10, v25
    s_add_u32 s78, s78, 1
    s_cmp_gt_u32 s78, 1600000
    s_cbranch_scc1 L_she_57
    s_cmp_eq_u32 s10, 0
    s_cbranch_scc1 L_shl_58
L_she_57:
    s_lshl_b32 s11, s83, 11
    s_add_u32 s11, s11, s81
    s_lshl_b32 s12, s83, 13
    s_add_u32 s12, s12, s82
    s_add_u32 m0, s12, 0
    s_add_u32 s13, s11, 1024
    buffer_load_dwordx4 v2, s[60:63], s11 offen sc1 lds
    s_add_u32 m0, s12, 4096
    s_nop 0
    buffer_load_dwordx4 v2, s[60:63], s13 offen sc1 lds
    s_add_u32 s83, s83, 1
    s_and_b32 s83, s83, 7
    s_lshl_b32 s11, s83, 11
    s_add_u32 s11, s11, s81
    s_lshl_b32 s12, s83, 13
    s_add_u32 s12, s12, s82
    s_add_u32 m0, s12, 0
    s_add_u32 s13, s11, 1024
    buffer_load_dwordx4 v2, s[60:63], s11 offen sc1 lds
    s_add_u32 m0, s12, 4096
    s_nop 0
    buffer_load_dwordx4 v2, s[60:63], s13 offen sc1 lds
    s_add_u32 s83, s83, 1
    s_and_b32 s83, s83, 7
    s_waitcnt vmcnt(2)
    s_barrier
    s_lshl_b32 s11, s83, 11
    s_add_u32 s11, s11, s81
    s_lshl_b32 s12, s83, 13
    s_add_u32 s12, s12, s82
    s_add_u32 m0, s12, 0
    s_add_u32 s13, s11, 1024
    buffer_load_dwordx4 v2, s[60:63], s11 offen sc1 lds
    s_add_u32 m0, s12, 4096
    s_nop 0
    buffer_load_dwordx4 v2, s[60:63], s13 offen sc1 lds
    s_add_u32 s83, s83, 1
    s_and_b32 s83, s83, 7
    s_mul_i32 s11, s76, 80
    s_lshl_b32 s12, s9, 3
    s_add_u32 s11, s11, s12
    s_mul_i32 s11, s11, 3072
    s_add_u32 s12, s77, s80
    s_add_u32 m0, s12, 0
    s_add_u32 s11, s11, s79
    buffer_load_dwordx4 v18, s[52:55], s11 offen lds
    buffer_load_dwordx4 v19, s[52:55], s11 offen offset:1024 lds
    buffer_load_dwordx4 v20, s[52:55], s11 offen offset:2048 lds
    s_mul_i32 s11, s76, 80
    s_lshl_b32 s12, s9, 3
    s_add_u32 s11, s11, s12
    s_add_u32 s11, s11, 32
    s_mul_i32 s11, s11, 3072
    s_add_u32 s12, s77, s80
    s_add_u32 m0, s12, 12288
    s_add_u32 s11, s11, s79
    buffer_load_dwordx4 v18, s[52:55], s11 offen lds
    buffer_load_dwordx4 v19, s[52:55], s11 offen offset:1024 lds
    buffer_load_dwordx4 v20, s[52:55], s11 offen offset:2048 lds
    s_add_u32 s77, s77, 24576
    s_cmp_eq_u32 s77, 73728
    s_cselect_b32 s77, 0, s77
    s_add_u32 s76, s76, 1
    s_and_b32 s76, s76, 7
    s_waitcnt vmcnt(8)
    s_barrier
    s_lshl_b32 s11, s83, 11
    s_add_u32 s11, s11, s81
    s_lshl_b32 s12, s83, 13
    s_add_u32 s12, s12, s82
    s_add_u32 m0, s12, 0
    s_add_u32 s13, s11, 1024
    buffer_load_dwordx4 v2, s[60:63], s11 offen sc1 lds
    s_add_u32 m0, s12, 4096
    s_nop 0
    buffer_load_dwordx4 v2, s[60:63], s13 offen sc1 lds
    s_add_u32 s83, s83, 1
    s_and_b32 s83, s83, 7
    s_mul_i32 s11, s76, 80
    s_lshl_b32 s12, s9, 3
    s_add_u32 s11, s11, s12
    s_mul_i32 s11, s11, 3072
    s_add_u32 s12, s77, s80
    s_add_u32 m0, s12, 0
    s_add_u32 s11, s11, s79
    buffer_load_dwordx4 v18, s[52:55], s11 offen lds
    buffer_load_dwordx4 v19, s[52:55], s11 offen offset:1024 lds
    buffer_load_dwordx4 v20, s[52:55], s11 offen offset:2048 lds
    s_mul_i32 s11, s76, 80
    s_lshl_b32 s12, s9, 3
    s_add_u32 s11, s11, s12
    s_add_u32 s11, s11, 32
    s_mul_i32 s11, s11, 3072
    s_add_u32 s12, s77, s80
    s_add_u32 m0, s12, 12288
    s_add_u32 s11, s11, s79
    buffer_load_dwordx4 v18, s[52:55], s11 offen lds
    buffer_load_dwordx4 v19, s[52:55], s11 offen offset:1024 lds
    buffer_load_dwordx4 v20, s[52:55], s11 offen offset:2048 lds
    s_add_u32 s77, s77, 24576
    s_cmp_eq_u32 s77, 73728
    s_cselect_b32 s77, 0, s77
    s_add_u32 s76, s76, 1
    s_and_b32 s76, s76, 7
    s_waitcnt vmcnt(8)
    s_barrier
    s_lshl_b32 s11, s83, 11
    s_add_u32 s11, s11, s81
    s_lshl_b32 s12, s83, 13
    s_add_u32 s12, s12, s82
    s_add_u32 m0, s12, 0
    s_add_u32 s13, s11, 1024
    buffer_load_dwordx4 v2, s[60:63], s11 offen sc1 lds
    s_add_u32 m0, s12, 4096
    s_nop 0
    buffer_load_dwordx4 v2, s[60:63], s13 offen sc1 lds
    s_add_u32 s83, s83, 1
    s_and_b32 s83, s83, 7
    s_mul_i32 s11, s76, 80
    s_lshl_b32 s12, s9, 3
    s_add_u32 s11, s11, s12
    s_mul_i32 s11, s11, 3072
    s_add_u32 s12, s77, s80
    s_add_u32 m0, s12, 0
    s_add_u32 s11, s11, s79
    buffer_load_dwordx4 v18, s[52:55], s11 offen lds
    buffer_load_dwordx4 v19, s[52:55], s11 offen offset:1024 lds
    buffer_load_dwordx4 v20, s[52:55], s11 offen offset:2048 lds
    s_mul_i32 s11, s76, 80
    s_lshl_b32 s12, s9, 3
    s_add_u32 s11, s11, s12
    s_add_u32 s11, s11, 32
    s_mul_i32 s11, s11, 3072
    s_add_u32 s12, s77, s80
    s_add_u32 m0, s12, 12288
    s_add_u32 s11, s11, s79
    buffer_load_dwordx4 v18, s[52:55], s11 offen lds
    buffer_load_dwordx4 v19, s[52:55], s11 offen offset:1024 lds
    buffer_load_dwordx4 v20, s[52:55], s11 offen offset:2048 lds
    s_add_u32 s77, s77, 24576
    s_cmp_eq_u32 s77, 73728
    s_cselect_b32 s77, 0, s77
    s_add_u32 s76, s76, 1
    s_and_b32 s76, s76, 7
    s_waitcnt vmcnt(8)
    s_barrier
    s_lshl_b32 s11, s83, 11
    s_add_u32 s11, s11, s81
    s_lshl_b32 s12, s83, 13
    s_add_u32 s12, s12, s82
    s_add_u32 m0, s12, 0
    s_add_u32 s13, s11, 1024
    buffer_load_dwordx4 v2, s[60:63], s11 offen sc1 lds
    s_add_u32 m0, s12, 4096
    s_nop 0
    buffer_load_dwordx4 v2, s[60:63], s13 offen sc1 lds
    s_add_u32 s83, s83, 1
    s_and_b32 s83, s83, 7
    s_mul_i32 s11, s76, 80
    s_lshl_b32 s12, s9, 3
    s_add_u32 s11, s11, s12
    s_mul_i32 s11, s11, 3072
    s_add_u32 s12, s77, s80
    s_add_u32 m0, s12, 0
    s_add_u32 s11, s11, s79
    buffer_load_dwordx4 v18, s[52:55], s11 offen lds
    buffer_load_dwordx4 v19, s[52:55], s11 offen offset:1024 lds
    buffer_load_dwordx4 v20, s[52:55], s11 offen offset:2048 lds
    s_mul_i32 s11, s76, 80
    s_lshl_b32 s12, s9, 3
    s_add_u32 s11, s11, s12
    s_add_u32 s11, s11, 32
    s_mul_i32 s11, s11, 3072
    s_add_u32 s12, s77, s80
    s_add_u32 m0, s12, 12288
    s_add_u32 s11, s11, s79
    buffer_load_dwordx4 v18, s[52:55], s11 offen lds
    buffer_load_dwordx4 v19, s[52:55], s11 offen offset:1024 lds
    buffer_load_dwordx4 v20, s[52:55], s11 offen offset:2048 lds
    s_add_u32 s77, s77, 24576
    s_cmp_eq_u32 s77, 73728
    s_cselect_b32 s77, 0, s77
    s_add_u32 s76, s76, 1
    s_and_b32 s76, s76, 7
    s_waitcnt vmcnt(8)
    s_barrier
    s_lshl_b32 s11, s83, 11
    s_add_u32 s11, s11, s81
    s_lshl_b32 s12, s83, 13
    s_add_u32 s12, s12, s82
    s_add_u32 m0, s12, 0
    s_add_u32 s13, s11, 1024
    buffer_load_dwordx4 v2, s[60:63], s11 offen sc1 lds
    s_add_u32 m0, s12, 4096
    s_nop 0
    buffer_load_dwordx4 v2, s[60:63], s13 offen sc1 lds
    s_add_u32 s83, s83, 1
    s_and_b32 s83, s83, 7
    s_mul_i32 s11, s76, 80
    s_lshl_b32 s12, s9, 3
    s_add_u32 s11, s11, s12
    s_mul_i32 s11, s11, 3072
    s_add_u32 s12, s77, s80
    s_add_u32 m0, s12, 0
    s_add_u32 s11, s11, s79
    buffer_load_dwordx4 v18, s[52:55], s11 offen lds
    buffer_load_dwordx4 v19, s[52:55], s11 offen offset:1024 lds
    buffer_load_dwordx4 v20, s[52:55], s11 offen offset:2048 lds
    s_mul_i32 s11, s76, 80
    s_lshl_b32 s12, s9, 3
    s_add_u32 s11, s11, s12
    s_add_u32 s11, s11, 32
    s_mul_i32 s11, s11, 3072
    s_add_u32 s12, s77, s80
    s_add_u32 m0, s12, 12288
    s_add_u32 s11, s11, s79
    buffer_load_dwordx4 v18, s[52:55], s11 offen lds
    buffer_load_dwordx4 v19, s[52:55], s11 offen offset:1024 lds
    buffer_load_dwordx4 v20, s[52:55], s11 offen offset:2048 lds
    s_add_u32 s77, s77, 24576
    s_cmp_eq_u32 s77, 73728
    s_cselect_b32 s77, 0, s77
    s_add_u32 s76, s76, 1
    s_and_b32 s76, s76, 7
    s_waitcnt vmcnt(8)
    s_barrier
    s_lshl_b32 s11, s83, 11
    s_add_u32 s11, s11, s81
    s_lshl_b32 s12, s83, 13
    s_add_u32 s12, s12, s82
    s_add_u32 m0, s12, 0
    s_add_u32 s13, s11, 1024
    buffer_load_dwordx4 v2, s[60:63], s11 offen sc1 lds
    s_add_u32 m0, s12, 4096
    s_nop 0
    buffer_load_dwordx4 v2, s[60:63], s13 offen sc1 lds
    s_and_b32 s83, s38, 1
    s_add_u32 s83, s83, 8
    s_mul_i32 s11, s76, 80
    s_lshl_b32 s12, s9, 3
    s_add_u32 s11, s11, s12
    s_mul_i32 s11, s11, 3072
    s_add_u32 s12, s77, s80
    s_add_u32 m0, s12, 0
    s_add_u32 s11, s11, s79
    buffer_load_dwordx4 v18, s[52:55], s11 offen lds
    buffer_load_dwordx4 v19, s[52:55], s11 offen offset:1024 lds
    buffer_load_dwordx4 v20, s[52:55], s11 offen offset:2048 lds
    s_mul_i32 s11, s76, 80
    s_lshl_b32 s12, s9, 3
    s_add_u32 s11, s11, s12
    s_add_u32 s11, s11, 32
    s_mul_i32 s11, s11, 3072
    s_add_u32 s12, s77, s80
    s_add_u32 m0, s12, 12288
    s_add_u32 s11, s11, s79
    buffer_load_dwordx4 v18, s[52:55], s11 offen lds
    buffer_load_dwordx4 v19, s[52:55], s11 offen offset:1024 lds
    buffer_load_dwordx4 v20, s[52:55], s11 offen offset:2048 lds
    s_add_u32 s77, s77, 24576
    s_cmp_eq_u32 s77, 73728
    s_cselect_b32 s77, 0, s77
    s_and_b32 s76, s38, 1
    s_add_u32 s76, s76, 8
    s_waitcnt vmcnt(8)
    s_barrier
    s_lshl_b32 s11, s83, 11
    s_add_u32 s11, s11, s81
    s_lshl_b32 s12, s83, 13
    s_add_u32 s12, s12, s82
    s_add_u32 m0, s12, 0
    s_add_u32 s13, s11, 1024
    buffer_load_dwordx4 v2, s[60:63], s11 offen sc1 lds
    s_add_u32 m0, s12, 4096
    s_nop 0
    buffer_load_dwordx4 v2, s[60:63], s13 offen sc1 lds
    s_xor_b32 s83, s83, 1
    s_sub_u32 s11, s76, 8
    s_lshl_b32 s11, s11, 2
    s_lshr_b32 s12, s9, 1
    s_add_u32 s11, s11, s12
    s_mul_i32 s11, s11, 80
    s_and_b32 s12, s9, 1
    s_lshl_b32 s12, s12, 3
    s_add_u32 s11, s11, s12
    s_add_u32 s11, s11, 64
    s_mul_i32 s11, s11, 3072
    s_add_u32 s12, s77, s80
    s_add_u32 m0, s12, 0
    s_add_u32 s11, s11, s79
    buffer_load_dwordx4 v18, s[52:55], s11 offen lds
    buffer_load_dwordx4 v19, s[52:55], s11 offen offset:1024 lds
    buffer_load_dwordx4 v20, s[52:55], s11 offen offset:2048 lds
    s_sub_u32 s11, s76, 8
    s_lshl_b32 s11, s11, 2
    s_lshr_b32 s12, s9, 1
    s_add_u32 s11, s11, s12
    s_add_u32 s11, s11, 2
    s_mul_i32 s11, s11, 80
    s_and_b32 s12, s9, 1
    s_lshl_b32 s12, s12, 3
    s_add_u32 s11, s11, s12
    s_add_u32 s11, s11, 64
    s_mul_i32 s11, s11, 3072
    s_add_u32 s12, s77, s80
    s_add_u32 m0, s12, 12288
    s_add_u32 s11, s11, s79
    buffer_load_dwordx4 v18, s[52:55], s11 offen lds
    buffer_load_dwordx4 v19, s[52:55], s11 offen offset:1024 lds
    buffer_load_dwordx4 v20, s[52:55], s11 offen offset:2048 lds
    s_add_u32 s77, s77, 24576
    s_cmp_eq_u32 s77, 73728
    s_cselect_b32 s77, 0, s77
    s_xor_b32 s76, s76, 1
    s_waitcnt vmcnt(8)
    s_barrier
    s_lshl_b32 s11, s83, 11
    s_add_u32 s11, s11, s81
    s_lshl_b32 s12, s83, 13
    s_add_u32 s12, s12, s82
    s_add_u32 m0, s12, 0
    s_add_u32 s13, s11, 1024
    buffer_load_dwordx4 v2, s[60:63], s11 offen sc1 lds
    s_add_u32 m0, s12, 4096
    s_nop 0
    buffer_load_dwordx4 v2, s[60:63], s13 offen sc1 lds
    s_xor_b32 s83, s83, 1
    s_sub_u32 s11, s76, 8
    s_lshl_b32 s11, s11, 2
    s_lshr_b32 s12, s9, 1
    s_add_u32 s11, s11, s12
    s_mul_i32 s11, s11, 80
    s_and_b32 s12, s9, 1
    s_lshl_b32 s12, s12, 3
    s_add_u32 s11, s11, s12
    s_add_u32 s11, s11, 64
    s_mul_i32 s11, s11, 3072
    s_add_u32 s12, s77, s80
    s_add_u32 m0, s12, 0
    s_add_u32 s11, s11, s79
    buffer_load_dwordx4 v18, s[52:55], s11 offen lds
    buffer_load_dwordx4 v19, s[52:55], s11 offen offset:1024 lds
    buffer_load_dwordx4 v20, s[52:55], s11 offen offset:2048 lds
    s_sub_u32 s11, s76, 8
    s_lshl_b32 s11, s11, 2
    s_lshr_b32 s12, s9, 1
    s_add_u32 s11, s11, s12
    s_add_u32 s11, s11, 2
    s_mul_i32 s11, s11, 80
    s_and_b32 s12, s9, 1
    s_lshl_b32 s12, s12, 3
    s_add_u32 s11, s11, s12
    s_add_u32 s11, s11, 64
    s_mul_i32 s11, s11, 3072
    s_add_u32 s12, s77, s80
    s_add_u32 m0, s12, 12288
    s_add_u32 s11, s11, s79
    buffer_load_dwordx4 v18, s[52:55], s11 offen lds
    buffer_load_dwordx4 v19, s[52:55], s11 offen offset:1024 lds
    buffer_load_dwordx4 v20, s[52:55], s11 offen offset:2048 lds
    s_add_u32 s77, s77, 24576
    s_cmp_eq_u32 s77, 73728
    s_cselect_b32 s77, 0, s77
    s_xor_b32 s76, s76, 1
    v_mov_b32 v24, 156188
    s_mov_b32 s78, 0
L_lw_62:
    ds_read_b32 v25, v24
    s_waitcnt lgkmcnt(0)
    v_readfirstlane_b32 s10, v25
    s_add_u32 s78, s78, 1
    s_cmp_gt_u32 s78, 1600000
    s_cbranch_scc1 L_lwe_63
    s_cmp_eq_u32 s10, 0
    s_cbranch_scc1 L_lw_62
L_lwe_63:
    s_lshr_b32 s11, s2, 3
    s_mul_i32 s11, s11, 61440
    s_mul_i32 s12, s9, 15360
    s_add_u32 s11, s11, s12
    s_add_u32 s11, s11, 17825792
    buffer_load_dword v32, v34, s[60:63], s11 offen
    s_add_u32 s11, s11, 8192
    s_mov_b32 exec_hi, 0xffffff
    buffer_load_dword v32, v34, s[60:63], s11 offen
    s_mov_b64 exec, -1
    s_waitcnt vmcnt(10)
    s_barrier
    s_waitcnt vmcnt(2)
    s_barrier
    s_barrier
    s_cmp_eq_u32 s9, 3
    s_cbranch_scc1 L_p5no_64
    s_mul_i32 s79, s6, 245760
    s_mul_i32 s11, s9, 10240
    s_add_u32 s79, s79, s11
    s_add_u32 s79, s79, 17825792
    s_mul_i32 s80, s9, 10240
    s_add_u32 s80, s80, 0
    s_lshl_b32 s76, s38, 1
    s_add_u32 s76, s76, 0
    s_and_b32 s76, s76, 7
    v_mov_b32 v24, 156188
    s_mov_b32 s78, 0
L_lw_66:
    ds_read_b32 v25, v24
    s_waitcnt lgkmcnt(0)
    v_readfirstlane_b32 s10, v25
    s_add_u32 s78, s78, 1
    s_cmp_gt_u32 s78, 1600000
    s_cbranch_scc1 L_lwe_67
    s_cmp_eq_u32 s10, 0
    s_cbranch_scc1 L_lw_66
L_lwe_67:
    s_mul_i32 s11, s76, 30720
    s_add_u32 s11, s11, s79
    s_add_u32 m0, s80, 0
    s_add_u32 s12, s11, 4096
    buffer_load_dwordx4 v2, s[60:63], s11 offen sc1 lds
    s_waitcnt vmcnt(16)
    buffer_load_dwordx4 v2, s[60:63], s11 offen offset:1024 sc1 lds
    s_waitcnt vmcnt(16)
    buffer_load_dwordx4 v2, s[60:63], s11 offen offset:2048 sc1 lds
    s_waitcnt vmcnt(16)
    buffer_load_dwordx4 v2, s[60:63], s11 offen offset:3072 sc1 lds
    s_waitcnt vmcnt(16)
    s_add_u32 m0, m0, 4096
    s_add_u32 s11, s11, 5120
    buffer_load_dwordx4 v2, s[60:63], s12 offen sc1 lds
    s_waitcnt vmcnt(16)
    s_add_u32 m0, s80, 5120
    s_add_u32 s12, s11, 4096
    buffer_load_dwordx4 v2, s[60:63], s11 offen sc1 lds
    s_waitcnt vmcnt(16)
    buffer_load_dwordx4 v2, s[60:63], s11 offen offset:1024 sc1 lds
    s_waitcnt vmcnt(16)
    buffer_load_dwordx4 v2, s[60:63], s11 offen offset:2048 sc1 lds
    s_waitcnt vmcnt(16)
    buffer_load_dwordx4 v2, s[60:63], s11 offen offset:3072 sc1 lds
    s_waitcnt vmcnt(16)
    s_add_u32 m0, m0, 4096
    s_add_u32 s11, s11, 5120
    buffer_load_dwordx4 v2, s[60:63], s12 offen sc1 lds
    s_waitcnt vmcnt(16)
    s_add_u32 s76, s76, 1
    s_and_b32 s76, s76, 7
    s_mul_i32 s11, s76, 30720
    s_add_u32 s11, s11, s79
    s_add_u32 m0, s80, 30720
    s_add_u32 s12, s11, 4096
    buffer_load_dwordx4 v2, s[60:63], s11 offen sc1 lds
    s_waitcnt vmcnt(16)
    buffer_load_dwordx4 v2, s[60:63], s11 offen offset:1024 sc1 lds
    s_waitcnt vmcnt(16)
    buffer_load_dwordx4 v2, s[60:63], s11 offen offset:2048 sc1 lds
    s_waitcnt vmcnt(16)
    buffer_load_dwordx4 v2, s[60:63], s11 offen offset:3072 sc1 lds
    s_waitcnt vmcnt(16)
    s_add_u32 m0, m0, 4096
    s_add_u32 s11, s11, 5120
    buffer_load_dwordx4 v2, s[60:63], s12 offen sc1 lds
    s_waitcnt vmcnt(16)
    s_add_u32 m0, s80, 35840
    s_add_u32 s12, s11, 4096
    buffer_load_dwordx4 v2, s[60:63], s11 offen sc1 lds
    s_waitcnt vmcnt(16)
    buffer_load_dwordx4 v2, s[60:63], s11 offen offset:1024 sc1 lds
    s_waitcnt vmcnt(16)
    buffer_load_dwordx4 v2, s[60:63], s11 offen offset:2048 sc1 lds
    s_waitcnt vmcnt(16)
    buffer_load_dwordx4 v2, s[60:63], s11 offen offset:3072 sc1 lds
    s_waitcnt vmcnt(16)
    s_add_u32 m0, m0, 4096
    s_add_u32 s11, s11, 5120
    buffer_load_dwordx4 v2, s[60:63], s12 offen sc1 lds
    s_waitcnt vmcnt(16)
    s_add_u32 s76, s76, 1
    s_and_b32 s76, s76, 7
    s_mul_i32 s11, s76, 30720
    s_add_u32 s11, s11, s79
    s_add_u32 m0, s80, 61440
    s_add_u32 s12, s11, 4096
    buffer_load_dwordx4 v2, s[60:63], s11 offen sc1 lds
    s_waitcnt vmcnt(16)
    buffer_load_dwordx4 v2, s[60:63], s11 offen offset:1024 sc1 lds
    s_waitcnt vmcnt(16)
    buffer_load_dwordx4 v2, s[60:63], s11 offen offset:2048 sc1 lds
    s_waitcnt vmcnt(16)
    buffer_load_dwordx4 v2, s[60:63], s11 offen offset:3072 sc1 lds
    s_waitcnt vmcnt(16)
    s_add_u32 m0, m0, 4096
    s_add_u32 s11, s11, 5120
    buffer_load_dwordx4 v2, s[60:63], s12 offen sc1 lds
    s_waitcnt vmcnt(16)
    s_add_u32 m0, s80, 66560
    s_add_u32 s12, s11, 4096
    buffer_load_dwordx4 v2, s[60:63], s11 offen sc1 lds
    s_waitcnt vmcnt(16)
    buffer_load_dwordx4 v2, s[60:63], s11 offen offset:1024 sc1 lds
    s_waitcnt vmcnt(16)
    buffer_load_dwordx4 v2, s[60:63], s11 offen offset:2048 sc1 lds
    s_waitcnt vmcnt(16)
    buffer_load_dwordx4 v2, s[60:63], s11 offen offset:3072 sc1 lds
    s_waitcnt vmcnt(16)
    s_add_u32 m0, m0, 4096
    s_add_u32 s11, s11, 5120
    buffer_load_dwordx4 v2, s[60:63], s12 offen sc1 lds
    s_waitcnt vmcnt(16)
    s_add_u32 s76, s76, 1
    s_and_b32 s76, s76, 7
    s_mul_i32 s11, s76, 30720
    s_add_u32 s11, s11, s79
    s_add_u32 m0, s80, 92160
    s_add_u32 s12, s11, 4096
    buffer_load_dwordx4 v2, s[60:63], s11 offen sc1 lds
    s_waitcnt vmcnt(16)
    buffer_load_dwordx4 v2, s[60:63], s11 offen offset:1024 sc1 lds
    s_waitcnt vmcnt(16)
    buffer_load_dwordx4 v2, s[60:63], s11 offen offset:2048 sc1 lds
    s_waitcnt vmcnt(16)
    buffer_load_dwordx4 v2, s[60:63], s11 offen offset:3072 sc1 lds
    s_waitcnt vmcnt(16)
    s_add_u32 m0, m0, 4096
    s_add_u32 s11, s11, 5120
    buffer_load_dwordx4 v2, s[60:63], s12 offen sc1 lds
    s_waitcnt vmcnt(16)
    s_add_u32 m0, s80, 97280
    s_add_u32 s12, s11, 4096
    buffer_load_dwordx4 v2, s[60:63], s11 offen sc1 lds
    s_waitcnt vmcnt(16)
    buffer_load_dwordx4 v2, s[60:63], s11 offen offset:1024 sc1 lds
    s_waitcnt vmcnt(16)
    buffer_load_dwordx4 v2, s[60:63], s11 offen offset:2048 sc1 lds
    s_waitcnt vmcnt(16)
    buffer_load_dwordx4 v2, s[60:63], s11 offen offset:3072 sc1 lds
    s_waitcnt vmcnt(16)
    s_add_u32 m0, m0, 4096
    s_add_u32 s11, s11, 5120
    buffer_load_dwordx4 v2, s[60:63], s12 offen sc1 lds
    s_waitcnt vmcnt(16)
    s_add_u32 s76, s76, 1
    s_and_b32 s76, s76, 7
    s_mul_i32 s11, s76, 30720
    s_add_u32 s11, s11, s79
    s_add_u32 m0, s80, 122880
    s_add_u32 s12, s11, 4096
    buffer_load_dwordx4 v2, s[60:63], s11 offen sc1 lds
    s_waitcnt vmcnt(16)
    buffer_load_dwordx4 v2, s[60:63], s11 offen offset:1024 sc1 lds
    s_waitcnt vmcnt(16)
    buffer_load_dwordx4 v2, s[60:63], s11 offen offset:2048 sc1 lds
    s_waitcnt vmcnt(16)
    buffer_load_dwordx4 v2, s[60:63], s11 offen offset:3072 sc1 lds
    s_waitcnt vmcnt(16)
    s_add_u32 m0, m0, 4096
    s_add_u32 s11, s11, 5120
    buffer_load_dwordx4 v2, s[60:63], s12 offen sc1 lds
    s_waitcnt vmcnt(16)
    s_add_u32 m0, s80, 128000
    s_add_u32 s12, s11, 4096
    buffer_load_dwordx4 v2, s[60:63], s11 offen sc1 lds
    s_waitcnt vmcnt(16)
    buffer_load_dwordx4 v2, s[60:63], s11 offen offset:1024 sc1 lds
    s_waitcnt vmcnt(16)
    buffer_load_dwordx4 v2, s[60:63], s11 offen offset:2048 sc1 lds
    s_waitcnt vmcnt(16)
    buffer_load_dwordx4 v2, s[60:63], s11 offen offset:3072 sc1 lds
    s_waitcnt vmcnt(16)
    s_add_u32 m0, m0, 4096
    s_add_u32 s11, s11, 5120
    buffer_load_dwordx4 v2, s[60:63], s12 offen sc1 lds
    s_waitcnt vmcnt(16)
    s_add_u32 s76, s76, 1
    s_and_b32 s76, s76, 7
    s_waitcnt vmcnt(40)
    s_barrier
    s_waitcnt vmcnt(30)
    s_barrier
    s_waitcnt vmcnt(20)
    s_barrier
    s_mul_i32 s11, s76, 30720
    s_add_u32 s11, s11, s79
    s_add_u32 m0, s80, 0
    s_add_u32 s12, s11, 4096
    buffer_load_dwordx4 v2, s[60:63], s11 offen sc1 lds
    s_waitcnt vmcnt(16)
    buffer_load_dwordx4 v2, s[60:63], s11 offen offset:1024 sc1 lds
    s_waitcnt vmcnt(16)
    buffer_load_dwordx4 v2, s[60:63], s11 offen offset:2048 sc1 lds
    s_waitcnt vmcnt(16)
    buffer_load_dwordx4 v2, s[60:63], s11 offen offset:3072 sc1 lds
    s_waitcnt vmcnt(16)
    s_add_u32 m0, m0, 4096
    s_add_u32 s11, s11, 5120
    buffer_load_dwordx4 v2, s[60:63], s12 offen sc1 lds
    s_waitcnt vmcnt(16)
    s_add_u32 m0, s80, 5120
    s_add_u32 s12, s11, 4096
    buffer_load_dwordx4 v2, s[60:63], s11 offen sc1 lds
    s_waitcnt vmcnt(16)
    buffer_load_dwordx4 v2, s[60:63], s11 offen offset:1024 sc1 lds
    s_waitcnt vmcnt(16)
    buffer_load_dwordx4 v2, s[60:63], s11 offen offset:2048 sc1 lds
    s_waitcnt vmcnt(16)
    buffer_load_dwordx4 v2, s[60:63], s11 offen offset:3072 sc1 lds
    s_waitcnt vmcnt(16)
    s_add_u32 m0, m0, 4096
    s_add_u32 s11, s11, 5120
    buffer_load_dwordx4 v2, s[60:63], s12 offen sc1 lds
    s_waitcnt vmcnt(16)
    s_add_u32 s76, s76, 1
    s_and_b32 s76, s76, 7
    s_waitcnt vmcnt(20)
    s_barrier
    s_mul_i32 s11, s76, 30720
    s_add_u32 s11, s11, s79
    s_add_u32 m0, s80, 30720
    s_add_u32 s12, s11, 4096
    buffer_load_dwordx4 v2, s[60:63], s11 offen sc1 lds
    s_waitcnt vmcnt(16)
    buffer_load_dwordx4 v2, s[60:63], s11 offen offset:1024 sc1 lds
    s_waitcnt vmcnt(16)
    buffer_load_dwordx4 v2, s[60:63], s11 offen offset:2048 sc1 lds
    s_waitcnt vmcnt(16)
    buffer_load_dwordx4 v2, s[60:63], s11 offen offset:3072 sc1 lds
    s_waitcnt vmcnt(16)
    s_add_u32 m0, m0, 4096
    s_add_u32 s11, s11, 5120
    buffer_load_dwordx4 v2, s[60:63], s12 offen sc1 lds
    s_waitcnt vmcnt(16)
    s_add_u32 m0, s80, 35840
    s_add_u32 s12, s11, 4096
    buffer_load_dwordx4 v2, s[60:63], s11 offen sc1 lds
    s_waitcnt vmcnt(16)
    buffer_load_dwordx4 v2, s[60:63], s11 offen offset:1024 sc1 lds
    s_waitcnt vmcnt(16)
    buffer_load_dwordx4 v2, s[60:63], s11 offen offset:2048 sc1 lds
    s_waitcnt vmcnt(16)
    buffer_load_dwordx4 v2, s[60:63], s11 offen offset:3072 sc1 lds
    s_waitcnt vmcnt(16)
    s_add_u32 m0, m0, 4096
    s_add_u32 s11, s11, 5120
    buffer_load_dwordx4 v2, s[60:63], s12 offen sc1 lds
    s_waitcnt vmcnt(16)
    s_add_u32 s76, s76, 1
    s_and_b32 s76, s76, 7
    s_waitcnt vmcnt(20)
    s_barrier
    s_mul_i32 s11, s76, 30720
    s_add_u32 s11, s11, s79
    s_add_u32 m0, s80, 61440
    s_add_u32 s12, s11, 4096
    buffer_load_dwordx4 v2, s[60:63], s11 offen sc1 lds
    s_waitcnt vmcnt(16)
    buffer_load_dwordx4 v2, s[60:63], s11 offen offset:1024 sc1 lds
    s_waitcnt vmcnt(16)
    buffer_load_dwordx4 v2, s[60:63], s11 offen offset:2048 sc1 lds
    s_waitcnt vmcnt(16)
    buffer_load_dwordx4 v2, s[60:63], s11 offen offset:3072 sc1 lds
    s_waitcnt vmcnt(16)
    s_add_u32 m0, m0, 4096
    s_add_u32 s11, s11, 5120
    buffer_load_dwordx4 v2, s[60:63], s12 offen sc1 lds
    s_waitcnt vmcnt(16)
    s_add_u32 m0, s80, 66560
    s_add_u32 s12, s11, 4096
    buffer_load_dwordx4 v2, s[60:63], s11 offen sc1 lds
    s_waitcnt vmcnt(16)
    buffer_load_dwordx4 v2, s[60:63], s11 offen offset:1024 sc1 lds
    s_waitcnt vmcnt(16)
    buffer_load_dwordx4 v2, s[60:63], s11 offen offset:2048 sc1 lds
    s_waitcnt vmcnt(16)
    buffer_load_dwordx4 v2, s[60:63], s11 offen offset:3072 sc1 lds
    s_waitcnt vmcnt(16)
    s_add_u32 m0, m0, 4096
    s_add_u32 s11, s11, 5120
    buffer_load_dwordx4 v2, s[60:63], s12 offen sc1 lds
    s_waitcnt vmcnt(16)
    s_add_u32 s76, s76, 1
    s_and_b32 s76, s76, 7
    s_waitcnt vmcnt(20)
    s_barrier
    s_waitcnt vmcnt(10)
    s_barrier
    s_waitcnt vmcnt(0)
    s_barrier
    s_branch L_p5done_65
L_p5no_64:
    s_waitcnt lgkmcnt(0)
    s_barrier
    s_barrier
    s_barrier
    s_barrier
    s_barrier
    s_barrier
    s_barrier
    s_barrier
L_p5done_65:
    s_endpgm
L_exit:
    s_endpgm
.section .rodata,"a"
.p2align 6
.amdhsa_kernel sequential_preLN__linear_attn_block__dense_activation_gelu__prompt_kernel
  .amdhsa_next_free_vgpr 256
  .amdhsa_next_free_sgpr 102
  .amdhsa_accum_offset 256
  .amdhsa_group_segment_fixed_size 0
  .amdhsa_kernarg_size 88
  .amdhsa_user_sgpr_count 2
  .amdhsa_user_sgpr_kernarg_segment_ptr 1
  .amdhsa_system_sgpr_workgroup_id_x 1
.end_amdhsa_kernel
```
